```python
import torch

def _softmax(x, axis=-1):
    return torch.softmax(x, dim=axis)
def _gelu(x):
    return torch.nn.functional.gelu(x, approximate="tanh")
def _silu(x):
    return torch.nn.functional.silu(x)
def _sigmoid(x):
    return torch.sigmoid(x)
def _layernorm(x, axis=-1, eps=1e-5):
    m = x.mean(dim=axis, keepdim=True)
    v = x.var(dim=axis, keepdim=True, unbiased=False)
    return (x - m) / torch.sqrt(v + eps)
def _scatter_add(tgt, idx, src, axis=0):
    return tgt.clone().index_add_(axis, idx, src)
def _segment_sum(src, seg, n):
    out = torch.zeros((n,) + src.shape[1:], dtype=src.dtype)
    return out.index_add_(0, seg, src)
def _pad(x, pw):
    flat = tuple(v for pair in reversed(pw) for v in pair)
    return torch.nn.functional.pad(x, flat)

kernel_name = 'sequential_preLN__ssm_conv_s4__geglu_ffn__prompt'

def setup_inputs():

    _w = (lambda a: (lambda t: t.to(torch.bfloat16) if t.is_floating_point() else t)(torch.as_tensor(a)))
    def _A_setup():
        B, L, D, N = 1, 2048, 448, 256
        A_re = -(lambda _x: torch.exp(torch.as_tensor(_x)))((lambda *s: torch.randn(*s, dtype=torch.bfloat16) * 3.2)(D, N))
        A_im = torch.pi * (lambda *s: torch.randn(*s, dtype=torch.bfloat16) * 0.05)(D, N)
        B_re = (lambda *s: torch.randn(*s, dtype=torch.bfloat16) * 0.05)(D, N)
        B_im = (lambda *s: torch.randn(*s, dtype=torch.bfloat16) * 0.05)(D, N)
        C_re = (lambda *s: torch.randn(*s, dtype=torch.bfloat16) * 0.05)(D, N)
        C_im = (lambda *s: torch.randn(*s, dtype=torch.bfloat16) * 0.05)(D, N)
        log_dt = (lambda *s: torch.randn(*s, dtype=torch.bfloat16) * 0.05)(D) * 0.5 - 4.0
        Dskip = (lambda *s: torch.randn(*s, dtype=torch.bfloat16) * 0.05)(D)
        return {
            "u": _w((lambda *s: torch.randn(*s, dtype=torch.bfloat16) * 0.05)(B, L, D)),
            "A_re": _w(A_re),
            "A_im": _w(A_im),
            "B_re": _w(B_re),
            "B_im": _w(B_im),
            "C_re": _w(C_re),
            "C_im": _w(C_im),
            "log_dt": _w(log_dt),
            "Dskip": _w(Dskip),
        }
    _A_in = _A_setup()

    def _B_setup():
        B, S, D, F = 1, 2048, 448, 1792
        return {
            "x": _w((lambda *s: torch.randn(*s, dtype=torch.bfloat16) * 0.05)(B, S, D)),
            "w_gate": _w((lambda *s: torch.randn(*s, dtype=torch.bfloat16) * 0.05)(D, F)),
            "w_up": _w((lambda *s: torch.randn(*s, dtype=torch.bfloat16) * 0.05)(D, F)),
            "w_down": _w((lambda *s: torch.randn(*s, dtype=torch.bfloat16) * 0.05)(F, D)),
        }
    _B_in = _B_setup()

    return {
        "A_u": _A_in["u"],
        "A_A_re": _A_in["A_re"],
        "A_A_im": _A_in["A_im"],
        "A_B_re": _A_in["B_re"],
        "A_B_im": _A_in["B_im"],
        "A_C_re": _A_in["C_re"],
        "A_C_im": _A_in["C_im"],
        "A_log_dt": _A_in["log_dt"],
        "A_Dskip": _A_in["Dskip"],
        "B_x": _B_in["x"],
        "B_w_gate": _B_in["w_gate"],
        "B_w_up": _B_in["w_up"],
        "B_w_down": _B_in["w_down"],
    }

def reference(A_u, A_A_re, A_A_im, A_B_re, A_B_im, A_C_re, A_C_im, A_log_dt, A_Dskip, B_x, B_w_gate, B_w_up, B_w_down):
    def _A_ref(u, A_re, A_im, B_re, B_im, C_re, C_im, log_dt, Dskip):
        Bsz, L, D = u.shape
        dt = torch.exp(log_dt)[:, None]
        A = A_re + 1j * A_im
        Bc = B_re + 1j * B_im
        Cc = C_re + 1j * C_im
        logdA = dt * A
        dB = dt * Bc
        l = (lambda x, dt: x.to(dt))(torch.arange(L), A_re.dtype)
        P = torch.exp(logdA[:, :, None] * l[None, None, :])
        K = torch.einsum("dn,dnl,dn->dl", Cc, P, dB).real
        L2 = 2 * L
        Kp = _pad(K, ((0, 0), (0, L)))
        up = (lambda x, *d: x.permute(*d))(u, 0, 2, 1)
        up = _pad(up, ((0, 0), (0, 0), (0, L)))
        Kf = (lambda x, axes=(-2,-1): torch.fft.rfft2(x.float(), dim=axes))(Kp[:, None, :], axes=(-2, -1))
        Uf = (lambda x, axes=(-2,-1): torch.fft.rfft2(x.float(), dim=axes))(up[:, :, None, :], axes=(-2, -1))
        Yf = Uf * Kf[None, :, :, :]
        y = (lambda x, s, axes=(-2,-1): torch.fft.irfft2(x, s=s, dim=axes).to(torch.bfloat16))(Yf, (1, L2), axes=(-2, -1))[:, :, 0, :L]
        y = (lambda x, *d: x.permute(*d))(y, 0, 2, 1) + u * Dskip[None, None, :]
        return y

    def _B_ref(x, w_gate, w_up, w_down):
        return (_gelu(x @ w_gate) * (x @ w_up)) @ w_down

    x = A_u
    h = x + _A_ref(_layernorm(x, axis=-1), A_A_re, A_A_im, A_B_re, A_B_im, A_C_re, A_C_im, A_log_dt, A_Dskip)
    h2 = h + _B_ref(_layernorm(h, axis=-1), B_w_gate, B_w_up, B_w_down)
    return h2
```

```asm
; @launch kernel=k1_kernel grid=(744,1,1) block=(256,1,1) lds=53504
; @launch kernel=k2_kernel grid=(448,1,1) block=(256,1,1) lds=38400
; @launch kernel=k3_kernel grid=(256,1,1) block=(512,1,1) lds=163840
; @launch kernel=k4_kernel grid=(224,1,1) block=(256,1,1) lds=73728
.amdgcn_target "amdgcn-amd-amdhsa--gfx950"
.text
.globl k1_kernel
.p2align 8
.type k1_kernel,@function
k1_kernel:
    s_cmp_ge_u32 s2, 744
    s_cbranch_scc1 L_k1_exit
    s_cmp_lt_u32 s2, 448
    s_cbranch_scc1 L_k1_kgen
    s_cmp_lt_u32 s2, 576
    s_cbranch_scc1 L_k1_ln1
    s_sub_u32 s3, s2, 576
    s_load_dwordx4 s[4:7], s[0:1], 80
    s_load_dwordx2 s[28:29], s[0:1], 96
    s_load_dwordx2 s[30:31], s[0:1], 120
    v_and_b32 v1, 63, v0
    v_lshrrev_b32 v2, 6, v0
    s_nop 0
    v_readfirstlane_b32 s20, v2
    s_waitcnt lgkmcnt(0)
    s_mov_b32 s16, s30
    s_and_b32 s17, s31, 0xffff
    s_mov_b32 s18, 0x1900000
    s_mov_b32 s19, 0x20000
    s_cmp_ge_u32 s3, 112
    s_cbranch_scc1 L_wp_down
    s_mov_b32 s8, s4
    s_and_b32 s9, s5, 0xffff
    s_mov_b32 s10, 0x188000
    s_mov_b32 s11, 0x20000
    s_mov_b32 s12, s6
    s_and_b32 s13, s7, 0xffff
    s_mov_b32 s14, 0x188000
    s_mov_b32 s15, 0x20000
    v_and_b32 v3, 15, v1
    v_lshrrev_b32 v4, 4, v1
    v_bfe_u32 v6, v3, 2, 1
    v_lshlrev_b32 v6, 3, v6
    v_bfe_u32 v7, v3, 3, 1
    v_lshl_add_u32 v6, v7, 2, v6
    v_and_b32 v7, 3, v3
    v_add_u32 v6, v6, v7
    s_lshl_b32 s21, s3, 4
    v_add_u32 v6, s21, v6
    v_lshlrev_b32 v6, 1, v6
    v_mul_u32_u24 v7, 28672, v4
    v_add_u32 v10, v6, v7
    v_add_u32 v11, 3584, v10
    v_add_u32 v12, 7168, v10
    v_add_u32 v13, 10752, v10
    v_add_u32 v14, 14336, v10
    v_add_u32 v15, 17920, v10
    v_add_u32 v16, 21504, v10
    v_add_u32 v17, 25088, v10
    v_lshrrev_b32 v6, 1, v4
    v_lshlrev_b32 v6, 10, v6
    v_and_b32 v7, 1, v4
    v_lshl_add_u32 v6, v7, 9, v6
    v_lshl_add_u32 v6, v3, 4, v6
    s_mul_i32 s22, s20, 114688
    s_mul_i32 s24, s3, 28672
    s_lshl_b32 s25, s20, 11
    s_add_u32 s24, s24, s25
    s_add_u32 s24, s24, 8388608
    v_mov_b32 v110, 0
    v_mov_b32 v111, 0
    s_mov_b32 s26, 0x3f803f80
    buffer_load_ushort v40, v10, s[8:11], s22 offen
    buffer_load_ushort v48, v10, s[12:15], s22 offen
    buffer_load_ushort v41, v11, s[8:11], s22 offen
    buffer_load_ushort v49, v11, s[12:15], s22 offen
    buffer_load_ushort v42, v12, s[8:11], s22 offen
    buffer_load_ushort v50, v12, s[12:15], s22 offen
    buffer_load_ushort v43, v13, s[8:11], s22 offen
    buffer_load_ushort v51, v13, s[12:15], s22 offen
    buffer_load_ushort v44, v14, s[8:11], s22 offen
    buffer_load_ushort v52, v14, s[12:15], s22 offen
    buffer_load_ushort v45, v15, s[8:11], s22 offen
    buffer_load_ushort v53, v15, s[12:15], s22 offen
    buffer_load_ushort v46, v16, s[8:11], s22 offen
    buffer_load_ushort v54, v16, s[12:15], s22 offen
    buffer_load_ushort v47, v17, s[8:11], s22 offen
    buffer_load_ushort v55, v17, s[12:15], s22 offen
    s_add_u32 s22, s22, 458752
    buffer_load_ushort v56, v10, s[8:11], s22 offen
    buffer_load_ushort v64, v10, s[12:15], s22 offen
    buffer_load_ushort v57, v11, s[8:11], s22 offen
    buffer_load_ushort v65, v11, s[12:15], s22 offen
    buffer_load_ushort v58, v12, s[8:11], s22 offen
    buffer_load_ushort v66, v12, s[12:15], s22 offen
    buffer_load_ushort v59, v13, s[8:11], s22 offen
    buffer_load_ushort v67, v13, s[12:15], s22 offen
    buffer_load_ushort v60, v14, s[8:11], s22 offen
    buffer_load_ushort v68, v14, s[12:15], s22 offen
    buffer_load_ushort v61, v15, s[8:11], s22 offen
    buffer_load_ushort v69, v15, s[12:15], s22 offen
    buffer_load_ushort v62, v16, s[8:11], s22 offen
    buffer_load_ushort v70, v16, s[12:15], s22 offen
    buffer_load_ushort v63, v17, s[8:11], s22 offen
    buffer_load_ushort v71, v17, s[12:15], s22 offen
    s_add_u32 s22, s22, 458752
    buffer_load_ushort v72, v10, s[8:11], s22 offen
    buffer_load_ushort v80, v10, s[12:15], s22 offen
    buffer_load_ushort v73, v11, s[8:11], s22 offen
    buffer_load_ushort v81, v11, s[12:15], s22 offen
    buffer_load_ushort v74, v12, s[8:11], s22 offen
    buffer_load_ushort v82, v12, s[12:15], s22 offen
    buffer_load_ushort v75, v13, s[8:11], s22 offen
    buffer_load_ushort v83, v13, s[12:15], s22 offen
    buffer_load_ushort v76, v14, s[8:11], s22 offen
    buffer_load_ushort v84, v14, s[12:15], s22 offen
    buffer_load_ushort v77, v15, s[8:11], s22 offen
    buffer_load_ushort v85, v15, s[12:15], s22 offen
    buffer_load_ushort v78, v16, s[8:11], s22 offen
    buffer_load_ushort v86, v16, s[12:15], s22 offen
    buffer_load_ushort v79, v17, s[8:11], s22 offen
    buffer_load_ushort v87, v17, s[12:15], s22 offen
    s_add_u32 s22, s22, 458752
    s_waitcnt vmcnt(32)
    v_lshl_or_b32 v20, v41, 16, v40
    v_lshl_or_b32 v21, v43, 16, v42
    v_lshl_or_b32 v22, v45, 16, v44
    v_lshl_or_b32 v23, v47, 16, v46
    v_lshl_or_b32 v24, v49, 16, v48
    v_lshl_or_b32 v25, v51, 16, v50
    v_lshl_or_b32 v26, v53, 16, v52
    v_lshl_or_b32 v27, v55, 16, v54
    buffer_store_dwordx4 v[20:23], v6, s[16:19], s24 offen
    buffer_store_dwordx4 v[24:27], v6, s[16:19], s24 offen offset:256
    s_add_u32 s24, s24, 8192
    v_dot2_f32_bf16 v110, v20, s26, v110
    v_dot2_f32_bf16 v111, v24, s26, v111
    v_dot2_f32_bf16 v110, v21, s26, v110
    v_dot2_f32_bf16 v111, v25, s26, v111
    v_dot2_f32_bf16 v110, v22, s26, v110
    v_dot2_f32_bf16 v111, v26, s26, v111
    v_dot2_f32_bf16 v110, v23, s26, v110
    v_dot2_f32_bf16 v111, v27, s26, v111
    buffer_load_ushort v88, v10, s[8:11], s22 offen
    buffer_load_ushort v96, v10, s[12:15], s22 offen
    buffer_load_ushort v89, v11, s[8:11], s22 offen
    buffer_load_ushort v97, v11, s[12:15], s22 offen
    buffer_load_ushort v90, v12, s[8:11], s22 offen
    buffer_load_ushort v98, v12, s[12:15], s22 offen
    buffer_load_ushort v91, v13, s[8:11], s22 offen
    buffer_load_ushort v99, v13, s[12:15], s22 offen
    buffer_load_ushort v92, v14, s[8:11], s22 offen
    buffer_load_ushort v100, v14, s[12:15], s22 offen
    buffer_load_ushort v93, v15, s[8:11], s22 offen
    buffer_load_ushort v101, v15, s[12:15], s22 offen
    buffer_load_ushort v94, v16, s[8:11], s22 offen
    buffer_load_ushort v102, v16, s[12:15], s22 offen
    buffer_load_ushort v95, v17, s[8:11], s22 offen
    buffer_load_ushort v103, v17, s[12:15], s22 offen
    s_add_u32 s22, s22, 458752
    s_waitcnt vmcnt(34)
    v_lshl_or_b32 v28, v57, 16, v56
    v_lshl_or_b32 v29, v59, 16, v58
    v_lshl_or_b32 v30, v61, 16, v60
    v_lshl_or_b32 v31, v63, 16, v62
    v_lshl_or_b32 v32, v65, 16, v64
    v_lshl_or_b32 v33, v67, 16, v66
    v_lshl_or_b32 v34, v69, 16, v68
    v_lshl_or_b32 v35, v71, 16, v70
    buffer_store_dwordx4 v[28:31], v6, s[16:19], s24 offen
    buffer_store_dwordx4 v[32:35], v6, s[16:19], s24 offen offset:256
    s_add_u32 s24, s24, 8192
    v_dot2_f32_bf16 v110, v28, s26, v110
    v_dot2_f32_bf16 v111, v32, s26, v111
    v_dot2_f32_bf16 v110, v29, s26, v110
    v_dot2_f32_bf16 v111, v33, s26, v111
    v_dot2_f32_bf16 v110, v30, s26, v110
    v_dot2_f32_bf16 v111, v34, s26, v111
    v_dot2_f32_bf16 v110, v31, s26, v110
    v_dot2_f32_bf16 v111, v35, s26, v111
    s_waitcnt vmcnt(20)
    v_lshl_or_b32 v20, v73, 16, v72
    v_lshl_or_b32 v21, v75, 16, v74
    v_lshl_or_b32 v22, v77, 16, v76
    v_lshl_or_b32 v23, v79, 16, v78
    v_lshl_or_b32 v24, v81, 16, v80
    v_lshl_or_b32 v25, v83, 16, v82
    v_lshl_or_b32 v26, v85, 16, v84
    v_lshl_or_b32 v27, v87, 16, v86
    buffer_store_dwordx4 v[20:23], v6, s[16:19], s24 offen
    buffer_store_dwordx4 v[24:27], v6, s[16:19], s24 offen offset:256
    s_add_u32 s24, s24, 8192
    v_dot2_f32_bf16 v110, v20, s26, v110
    v_dot2_f32_bf16 v111, v24, s26, v111
    v_dot2_f32_bf16 v110, v21, s26, v110
    v_dot2_f32_bf16 v111, v25, s26, v111
    v_dot2_f32_bf16 v110, v22, s26, v110
    v_dot2_f32_bf16 v111, v26, s26, v111
    v_dot2_f32_bf16 v110, v23, s26, v110
    v_dot2_f32_bf16 v111, v27, s26, v111
    s_waitcnt vmcnt(4)
    v_lshl_or_b32 v28, v89, 16, v88
    v_lshl_or_b32 v29, v91, 16, v90
    v_lshl_or_b32 v30, v93, 16, v92
    v_lshl_or_b32 v31, v95, 16, v94
    v_lshl_or_b32 v32, v97, 16, v96
    v_lshl_or_b32 v33, v99, 16, v98
    v_lshl_or_b32 v34, v101, 16, v100
    v_lshl_or_b32 v35, v103, 16, v102
    s_cmp_ge_u32 s20, 2
    s_cbranch_scc1 L_wp_gu_done
    buffer_store_dwordx4 v[28:31], v6, s[16:19], s24 offen
    buffer_store_dwordx4 v[32:35], v6, s[16:19], s24 offen offset:256
    s_add_u32 s24, s24, 8192
    v_dot2_f32_bf16 v110, v28, s26, v110
    v_dot2_f32_bf16 v111, v32, s26, v111
    v_dot2_f32_bf16 v110, v29, s26, v110
    v_dot2_f32_bf16 v111, v33, s26, v111
    v_dot2_f32_bf16 v110, v30, s26, v110
    v_dot2_f32_bf16 v111, v34, s26, v111
    v_dot2_f32_bf16 v110, v31, s26, v110
    v_dot2_f32_bf16 v111, v35, s26, v111
L_wp_gu_done:
    s_nop 3
    s_lshl_b32 s25, s20, 9
    v_lshl_add_u32 v7, v1, 2, s25
    ds_write_b32 v7, v110
    ds_write_b32 v7, v111 offset:256
    s_waitcnt lgkmcnt(0)
    s_barrier
    v_cmp_gt_u32 vcc, 32, v0
    s_and_saveexec_b64 s[32:33], vcc
    s_cbranch_execz L_wp_end
    v_lshrrev_b32 v8, 4, v0
    v_lshlrev_b32 v8, 8, v8
    v_lshl_add_u32 v8, v3, 2, v8
    ds_read_b32 v30, v8 offset:0
    ds_read_b32 v31, v8 offset:64
    ds_read_b32 v32, v8 offset:128
    ds_read_b32 v33, v8 offset:192
    ds_read_b32 v34, v8 offset:512
    ds_read_b32 v35, v8 offset:576
    ds_read_b32 v36, v8 offset:640
    ds_read_b32 v37, v8 offset:704
    ds_read_b32 v38, v8 offset:1024
    ds_read_b32 v39, v8 offset:1088
    ds_read_b32 v40, v8 offset:1152
    ds_read_b32 v41, v8 offset:1216
    ds_read_b32 v42, v8 offset:1536
    ds_read_b32 v43, v8 offset:1600
    ds_read_b32 v44, v8 offset:1664
    ds_read_b32 v45, v8 offset:1728
    s_waitcnt lgkmcnt(0)
    v_add_f32 v30, v30, v31
    v_add_f32 v30, v30, v32
    v_add_f32 v30, v30, v33
    v_add_f32 v30, v30, v34
    v_add_f32 v30, v30, v35
    v_add_f32 v30, v30, v36
    v_add_f32 v30, v30, v37
    v_add_f32 v30, v30, v38
    v_add_f32 v30, v30, v39
    v_add_f32 v30, v30, v40
    v_add_f32 v30, v30, v41
    v_add_f32 v30, v30, v42
    v_add_f32 v30, v30, v43
    v_add_f32 v30, v30, v44
    v_add_f32 v30, v30, v45
    v_bfe_u32 v8, v0, 2, 1
    v_lshlrev_b32 v8, 4, v8
    v_lshrrev_b32 v9, 3, v0
    v_lshl_add_u32 v8, v9, 2, v8
    v_and_b32 v9, 3, v0
    v_add_u32 v8, v8, v9
    v_lshlrev_b32 v8, 2, v8
    s_lshl_b32 s25, s3, 7
    s_add_u32 s25, s25, 12058624
    buffer_store_dword v30, v8, s[16:19], s25 offen
L_wp_end:
    s_endpgm
L_wp_down:
    s_mov_b32 s8, s28
    s_and_b32 s9, s29, 0xffff
    s_mov_b32 s10, 0x188000
    s_mov_b32 s11, 0x20000
    s_sub_u32 s3, s3, 112
    s_lshr_b32 s21, s3, 2
    s_and_b32 s22, s3, 3
    s_mul_i32 s22, s22, 28
    s_mul_i32 s23, s20, 7
    s_add_u32 s22, s22, s23
    v_and_b32 v3, 31, v1
    v_lshrrev_b32 v4, 5, v1
    v_bfe_u32 v6, v3, 2, 1
    v_lshlrev_b32 v6, 4, v6
    v_lshrrev_b32 v7, 3, v3
    v_lshl_add_u32 v6, v7, 2, v6
    v_and_b32 v7, 3, v3
    v_add_u32 v6, v6, v7
    s_lshl_b32 s23, s21, 5
    v_add_u32 v6, s23, v6
    v_lshlrev_b32 v6, 1, v6
    v_mul_u32_u24 v7, 7168, v4
    v_add_u32 v10, v6, v7
    v_add_u32 v11, 3584, v10
    v_lshlrev_b32 v5, 4, v1
    s_mul_i32 s24, s22, 14336
    s_mul_i32 s25, s21, 112
    s_add_u32 s25, s25, s22
    s_lshl_b32 s25, s25, 10
    s_add_u32 s25, s25, 12582912
    buffer_load_ushort v60, v10, s[8:11], s24 offen offset:0
    buffer_load_ushort v61, v10, s[8:11], s24 offen offset:896
    buffer_load_ushort v62, v10, s[8:11], s24 offen offset:1792
    buffer_load_ushort v63, v10, s[8:11], s24 offen offset:2688
    buffer_load_ushort v64, v11, s[8:11], s24 offen offset:0
    buffer_load_ushort v65, v11, s[8:11], s24 offen offset:896
    buffer_load_ushort v66, v11, s[8:11], s24 offen offset:1792
    buffer_load_ushort v67, v11, s[8:11], s24 offen offset:2688
    s_add_u32 s24, s24, 14336
    buffer_load_ushort v68, v10, s[8:11], s24 offen offset:0
    buffer_load_ushort v69, v10, s[8:11], s24 offen offset:896
    buffer_load_ushort v70, v10, s[8:11], s24 offen offset:1792
    buffer_load_ushort v71, v10, s[8:11], s24 offen offset:2688
    buffer_load_ushort v72, v11, s[8:11], s24 offen offset:0
    buffer_load_ushort v73, v11, s[8:11], s24 offen offset:896
    buffer_load_ushort v74, v11, s[8:11], s24 offen offset:1792
    buffer_load_ushort v75, v11, s[8:11], s24 offen offset:2688
    s_add_u32 s24, s24, 14336
    buffer_load_ushort v76, v10, s[8:11], s24 offen offset:0
    buffer_load_ushort v77, v10, s[8:11], s24 offen offset:896
    buffer_load_ushort v78, v10, s[8:11], s24 offen offset:1792
    buffer_load_ushort v79, v10, s[8:11], s24 offen offset:2688
    buffer_load_ushort v80, v11, s[8:11], s24 offen offset:0
    buffer_load_ushort v81, v11, s[8:11], s24 offen offset:896
    buffer_load_ushort v82, v11, s[8:11], s24 offen offset:1792
    buffer_load_ushort v83, v11, s[8:11], s24 offen offset:2688
    s_add_u32 s24, s24, 14336
    buffer_load_ushort v84, v10, s[8:11], s24 offen offset:0
    buffer_load_ushort v85, v10, s[8:11], s24 offen offset:896
    buffer_load_ushort v86, v10, s[8:11], s24 offen offset:1792
    buffer_load_ushort v87, v10, s[8:11], s24 offen offset:2688
    buffer_load_ushort v88, v11, s[8:11], s24 offen offset:0
    buffer_load_ushort v89, v11, s[8:11], s24 offen offset:896
    buffer_load_ushort v90, v11, s[8:11], s24 offen offset:1792
    buffer_load_ushort v91, v11, s[8:11], s24 offen offset:2688
    s_add_u32 s24, s24, 14336
    buffer_load_ushort v92, v10, s[8:11], s24 offen offset:0
    buffer_load_ushort v93, v10, s[8:11], s24 offen offset:896
    buffer_load_ushort v94, v10, s[8:11], s24 offen offset:1792
    buffer_load_ushort v95, v10, s[8:11], s24 offen offset:2688
    buffer_load_ushort v96, v11, s[8:11], s24 offen offset:0
    buffer_load_ushort v97, v11, s[8:11], s24 offen offset:896
    buffer_load_ushort v98, v11, s[8:11], s24 offen offset:1792
    buffer_load_ushort v99, v11, s[8:11], s24 offen offset:2688
    s_add_u32 s24, s24, 14336
    buffer_load_ushort v100, v10, s[8:11], s24 offen offset:0
    buffer_load_ushort v101, v10, s[8:11], s24 offen offset:896
    buffer_load_ushort v102, v10, s[8:11], s24 offen offset:1792
    buffer_load_ushort v103, v10, s[8:11], s24 offen offset:2688
    buffer_load_ushort v104, v11, s[8:11], s24 offen offset:0
    buffer_load_ushort v105, v11, s[8:11], s24 offen offset:896
    buffer_load_ushort v106, v11, s[8:11], s24 offen offset:1792
    buffer_load_ushort v107, v11, s[8:11], s24 offen offset:2688
    s_add_u32 s24, s24, 14336
    buffer_load_ushort v108, v10, s[8:11], s24 offen offset:0
    buffer_load_ushort v109, v10, s[8:11], s24 offen offset:896
    buffer_load_ushort v110, v10, s[8:11], s24 offen offset:1792
    buffer_load_ushort v111, v10, s[8:11], s24 offen offset:2688
    buffer_load_ushort v112, v11, s[8:11], s24 offen offset:0
    buffer_load_ushort v113, v11, s[8:11], s24 offen offset:896
    buffer_load_ushort v114, v11, s[8:11], s24 offen offset:1792
    buffer_load_ushort v115, v11, s[8:11], s24 offen offset:2688
    s_add_u32 s24, s24, 14336
    s_waitcnt vmcnt(48)
    v_lshl_or_b32 v20, v61, 16, v60
    v_lshl_or_b32 v21, v63, 16, v62
    v_lshl_or_b32 v22, v65, 16, v64
    v_lshl_or_b32 v23, v67, 16, v66
    buffer_store_dwordx4 v[20:23], v5, s[16:19], s25 offen
    s_add_u32 s25, s25, 1024
    s_waitcnt vmcnt(41)
    v_lshl_or_b32 v24, v69, 16, v68
    v_lshl_or_b32 v25, v71, 16, v70
    v_lshl_or_b32 v26, v73, 16, v72
    v_lshl_or_b32 v27, v75, 16, v74
    buffer_store_dwordx4 v[24:27], v5, s[16:19], s25 offen
    s_add_u32 s25, s25, 1024
    s_waitcnt vmcnt(34)
    v_lshl_or_b32 v28, v77, 16, v76
    v_lshl_or_b32 v29, v79, 16, v78
    v_lshl_or_b32 v30, v81, 16, v80
    v_lshl_or_b32 v31, v83, 16, v82
    buffer_store_dwordx4 v[28:31], v5, s[16:19], s25 offen
    s_add_u32 s25, s25, 1024
    s_waitcnt vmcnt(27)
    v_lshl_or_b32 v32, v85, 16, v84
    v_lshl_or_b32 v33, v87, 16, v86
    v_lshl_or_b32 v34, v89, 16, v88
    v_lshl_or_b32 v35, v91, 16, v90
    buffer_store_dwordx4 v[32:35], v5, s[16:19], s25 offen
    s_add_u32 s25, s25, 1024
    s_waitcnt vmcnt(20)
    v_lshl_or_b32 v36, v93, 16, v92
    v_lshl_or_b32 v37, v95, 16, v94
    v_lshl_or_b32 v38, v97, 16, v96
    v_lshl_or_b32 v39, v99, 16, v98
    buffer_store_dwordx4 v[36:39], v5, s[16:19], s25 offen
    s_add_u32 s25, s25, 1024
    s_waitcnt vmcnt(13)
    v_lshl_or_b32 v40, v101, 16, v100
    v_lshl_or_b32 v41, v103, 16, v102
    v_lshl_or_b32 v42, v105, 16, v104
    v_lshl_or_b32 v43, v107, 16, v106
    buffer_store_dwordx4 v[40:43], v5, s[16:19], s25 offen
    s_add_u32 s25, s25, 1024
    s_waitcnt vmcnt(6)
    v_lshl_or_b32 v44, v109, 16, v108
    v_lshl_or_b32 v45, v111, 16, v110
    v_lshl_or_b32 v46, v113, 16, v112
    v_lshl_or_b32 v47, v115, 16, v114
    buffer_store_dwordx4 v[44:47], v5, s[16:19], s25 offen
    s_add_u32 s25, s25, 1024
    s_endpgm
L_k1_ln1:
    s_sub_u32 s3, s2, 448
    s_load_dwordx2 s[4:5], s[0:1], 0
    s_load_dwordx2 s[6:7], s[0:1], 120
    s_lshl_b32 s20, s3, 4
    v_lshrrev_b32 v1, 4, v0
    v_and_b32 v2, 15, v0
    v_add_u32 v3, s20, v1
    s_movk_i32 s21, 896
    v_mul_lo_u32 v3, v3, s21
    v_lshl_add_u32 v3, v2, 3, v3
    s_waitcnt lgkmcnt(0)
    s_mov_b32 s8, s4
    s_and_b32 s9, s5, 0xffff
    s_mov_b32 s10, 0x1c0000
    s_mov_b32 s11, 0x20000
    s_mov_b32 s12, s6
    s_and_b32 s13, s7, 0xffff
    s_mov_b32 s14, 0x1900000
    s_mov_b32 s15, 0x20000
    buffer_load_dwordx2 v[10:11], v3, s[8:11], 0 offen offset:0
    buffer_load_dwordx2 v[12:13], v3, s[8:11], 0 offen offset:128
    buffer_load_dwordx2 v[14:15], v3, s[8:11], 0 offen offset:256
    buffer_load_dwordx2 v[16:17], v3, s[8:11], 0 offen offset:384
    buffer_load_dwordx2 v[18:19], v3, s[8:11], 0 offen offset:512
    buffer_load_dwordx2 v[20:21], v3, s[8:11], 0 offen offset:640
    buffer_load_dwordx2 v[22:23], v3, s[8:11], 0 offen offset:768
    s_movk_i32 s21, 144
    v_mul_lo_u32 v4, v2, s21
    v_sub_u32 v5, 15, v1
    v_lshl_add_u32 v5, v5, 1, v4
    v_lshl_add_u32 v6, v1, 1, v4
    v_add_u32 v6, 16128, v6
    s_waitcnt vmcnt(0)
    v_lshlrev_b32 v30, 16, v10
    v_and_b32 v31, 0xffff0000, v10
    v_lshlrev_b32 v32, 16, v11
    v_and_b32 v33, 0xffff0000, v11
    v_lshlrev_b32 v34, 16, v12
    v_and_b32 v35, 0xffff0000, v12
    v_lshlrev_b32 v36, 16, v13
    v_and_b32 v37, 0xffff0000, v13
    v_lshlrev_b32 v38, 16, v14
    v_and_b32 v39, 0xffff0000, v14
    v_lshlrev_b32 v40, 16, v15
    v_and_b32 v41, 0xffff0000, v15
    v_lshlrev_b32 v42, 16, v16
    v_and_b32 v43, 0xffff0000, v16
    v_lshlrev_b32 v44, 16, v17
    v_and_b32 v45, 0xffff0000, v17
    v_lshlrev_b32 v46, 16, v18
    v_and_b32 v47, 0xffff0000, v18
    v_lshlrev_b32 v48, 16, v19
    v_and_b32 v49, 0xffff0000, v19
    v_lshlrev_b32 v50, 16, v20
    v_and_b32 v51, 0xffff0000, v20
    v_lshlrev_b32 v52, 16, v21
    v_and_b32 v53, 0xffff0000, v21
    v_lshlrev_b32 v54, 16, v22
    v_and_b32 v55, 0xffff0000, v22
    v_lshlrev_b32 v56, 16, v23
    v_and_b32 v57, 0xffff0000, v23
    v_pk_add_f32 v[60:61], v[30:31], v[32:33]
    v_pk_add_f32 v[60:61], v[60:61], v[34:35]
    v_pk_add_f32 v[60:61], v[60:61], v[36:37]
    v_pk_add_f32 v[60:61], v[60:61], v[38:39]
    v_pk_add_f32 v[60:61], v[60:61], v[40:41]
    v_pk_add_f32 v[60:61], v[60:61], v[42:43]
    v_pk_add_f32 v[60:61], v[60:61], v[44:45]
    v_pk_add_f32 v[60:61], v[60:61], v[46:47]
    v_pk_add_f32 v[60:61], v[60:61], v[48:49]
    v_pk_add_f32 v[60:61], v[60:61], v[50:51]
    v_pk_add_f32 v[60:61], v[60:61], v[52:53]
    v_pk_add_f32 v[60:61], v[60:61], v[54:55]
    v_pk_add_f32 v[60:61], v[60:61], v[56:57]
    v_add_f32 v60, v60, v61
    s_nop 1
    v_add_f32_dpp v62, v60, v60 quad_perm:[1,0,3,2] row_mask:0xf bank_mask:0xf
    v_mov_b32 v60, v62
    s_nop 1
    v_add_f32_dpp v62, v60, v60 quad_perm:[2,3,0,1] row_mask:0xf bank_mask:0xf
    v_mov_b32 v60, v62
    s_nop 1
    v_add_f32_dpp v62, v60, v60 row_half_mirror row_mask:0xf bank_mask:0xf
    v_mov_b32 v60, v62
    s_nop 1
    v_add_f32_dpp v62, v60, v60 row_mirror row_mask:0xf bank_mask:0xf
    v_mov_b32 v60, v62
    v_mul_f32 v60, 0x3b124925, v60
    v_mov_b32 v64, 0
    v_mov_b32 v65, 0
    v_pk_add_f32 v[66:67], v[30:31], v[60:61] op_sel_hi:[1,0] neg_lo:[0,1] neg_hi:[0,1]
    v_pk_fma_f32 v[64:65], v[66:67], v[66:67], v[64:65]
    v_pk_add_f32 v[66:67], v[32:33], v[60:61] op_sel_hi:[1,0] neg_lo:[0,1] neg_hi:[0,1]
    v_pk_fma_f32 v[64:65], v[66:67], v[66:67], v[64:65]
    v_pk_add_f32 v[66:67], v[34:35], v[60:61] op_sel_hi:[1,0] neg_lo:[0,1] neg_hi:[0,1]
    v_pk_fma_f32 v[64:65], v[66:67], v[66:67], v[64:65]
    v_pk_add_f32 v[66:67], v[36:37], v[60:61] op_sel_hi:[1,0] neg_lo:[0,1] neg_hi:[0,1]
    v_pk_fma_f32 v[64:65], v[66:67], v[66:67], v[64:65]
    v_pk_add_f32 v[66:67], v[38:39], v[60:61] op_sel_hi:[1,0] neg_lo:[0,1] neg_hi:[0,1]
    v_pk_fma_f32 v[64:65], v[66:67], v[66:67], v[64:65]
    v_pk_add_f32 v[66:67], v[40:41], v[60:61] op_sel_hi:[1,0] neg_lo:[0,1] neg_hi:[0,1]
    v_pk_fma_f32 v[64:65], v[66:67], v[66:67], v[64:65]
    v_pk_add_f32 v[66:67], v[42:43], v[60:61] op_sel_hi:[1,0] neg_lo:[0,1] neg_hi:[0,1]
    v_pk_fma_f32 v[64:65], v[66:67], v[66:67], v[64:65]
    v_pk_add_f32 v[66:67], v[44:45], v[60:61] op_sel_hi:[1,0] neg_lo:[0,1] neg_hi:[0,1]
    v_pk_fma_f32 v[64:65], v[66:67], v[66:67], v[64:65]
    v_pk_add_f32 v[66:67], v[46:47], v[60:61] op_sel_hi:[1,0] neg_lo:[0,1] neg_hi:[0,1]
    v_pk_fma_f32 v[64:65], v[66:67], v[66:67], v[64:65]
    v_pk_add_f32 v[66:67], v[48:49], v[60:61] op_sel_hi:[1,0] neg_lo:[0,1] neg_hi:[0,1]
    v_pk_fma_f32 v[64:65], v[66:67], v[66:67], v[64:65]
    v_pk_add_f32 v[66:67], v[50:51], v[60:61] op_sel_hi:[1,0] neg_lo:[0,1] neg_hi:[0,1]
    v_pk_fma_f32 v[64:65], v[66:67], v[66:67], v[64:65]
    v_pk_add_f32 v[66:67], v[52:53], v[60:61] op_sel_hi:[1,0] neg_lo:[0,1] neg_hi:[0,1]
    v_pk_fma_f32 v[64:65], v[66:67], v[66:67], v[64:65]
    v_pk_add_f32 v[66:67], v[54:55], v[60:61] op_sel_hi:[1,0] neg_lo:[0,1] neg_hi:[0,1]
    v_pk_fma_f32 v[64:65], v[66:67], v[66:67], v[64:65]
    v_pk_add_f32 v[66:67], v[56:57], v[60:61] op_sel_hi:[1,0] neg_lo:[0,1] neg_hi:[0,1]
    v_pk_fma_f32 v[64:65], v[66:67], v[66:67], v[64:65]
    v_add_f32 v63, v64, v65
    s_nop 1
    v_add_f32_dpp v62, v63, v63 quad_perm:[1,0,3,2] row_mask:0xf bank_mask:0xf
    v_mov_b32 v63, v62
    s_nop 1
    v_add_f32_dpp v62, v63, v63 quad_perm:[2,3,0,1] row_mask:0xf bank_mask:0xf
    v_mov_b32 v63, v62
    s_nop 1
    v_add_f32_dpp v62, v63, v63 row_half_mirror row_mask:0xf bank_mask:0xf
    v_mov_b32 v63, v62
    s_nop 1
    v_add_f32_dpp v62, v63, v63 row_mirror row_mask:0xf bank_mask:0xf
    v_mov_b32 v63, v62
    v_mul_f32 v63, 0x3b124925, v63
    v_cvt_pk_bf16_f32 v62, v60, v63
    v_lshlrev_b32 v64, 16, v62
    v_and_b32 v65, 0xffff0000, v62
    v_add_f32 v65, 0x3727c5ac, v65
    v_cvt_pk_bf16_f32 v62, v65, v65
    v_and_b32 v65, 0xffff0000, v62
    v_sqrt_f32 v65, v65
    s_nop 0
    v_cvt_pk_bf16_f32 v62, v65, v65
    v_and_b32 v65, 0xffff0000, v62
    v_rcp_f32 v66, v65
    v_pk_add_f32 v[30:31], v[30:31], v[64:65] op_sel_hi:[1,0] neg_lo:[0,1] neg_hi:[0,1]
    v_cvt_pk_bf16_f32 v67, v30, v31
    v_lshlrev_b32 v30, 16, v67
    v_and_b32 v31, 0xffff0000, v67
    v_pk_mul_f32 v[68:69], v[30:31], v[66:67] op_sel_hi:[1,0]
    v_pk_fma_f32 v[70:71], v[68:69], v[64:65], v[30:31] op_sel:[0,1,0] op_sel_hi:[1,1,1] neg_lo:[1,0,0] neg_hi:[1,0,0]
    v_pk_fma_f32 v[68:69], v[70:71], v[66:67], v[68:69] op_sel_hi:[1,0,1]
    v_cvt_pk_bf16_f32 v72, v68, v69
    v_pk_add_f32 v[32:33], v[32:33], v[64:65] op_sel_hi:[1,0] neg_lo:[0,1] neg_hi:[0,1]
    v_cvt_pk_bf16_f32 v67, v32, v33
    v_lshlrev_b32 v32, 16, v67
    v_and_b32 v33, 0xffff0000, v67
    v_pk_mul_f32 v[68:69], v[32:33], v[66:67] op_sel_hi:[1,0]
    v_pk_fma_f32 v[70:71], v[68:69], v[64:65], v[32:33] op_sel:[0,1,0] op_sel_hi:[1,1,1] neg_lo:[1,0,0] neg_hi:[1,0,0]
    v_pk_fma_f32 v[68:69], v[70:71], v[66:67], v[68:69] op_sel_hi:[1,0,1]
    v_cvt_pk_bf16_f32 v73, v68, v69
    v_pk_add_f32 v[34:35], v[34:35], v[64:65] op_sel_hi:[1,0] neg_lo:[0,1] neg_hi:[0,1]
    v_cvt_pk_bf16_f32 v67, v34, v35
    v_lshlrev_b32 v34, 16, v67
    v_and_b32 v35, 0xffff0000, v67
    v_pk_mul_f32 v[68:69], v[34:35], v[66:67] op_sel_hi:[1,0]
    v_pk_fma_f32 v[70:71], v[68:69], v[64:65], v[34:35] op_sel:[0,1,0] op_sel_hi:[1,1,1] neg_lo:[1,0,0] neg_hi:[1,0,0]
    v_pk_fma_f32 v[68:69], v[70:71], v[66:67], v[68:69] op_sel_hi:[1,0,1]
    v_cvt_pk_bf16_f32 v74, v68, v69
    v_pk_add_f32 v[36:37], v[36:37], v[64:65] op_sel_hi:[1,0] neg_lo:[0,1] neg_hi:[0,1]
    v_cvt_pk_bf16_f32 v67, v36, v37
    v_lshlrev_b32 v36, 16, v67
    v_and_b32 v37, 0xffff0000, v67
    v_pk_mul_f32 v[68:69], v[36:37], v[66:67] op_sel_hi:[1,0]
    v_pk_fma_f32 v[70:71], v[68:69], v[64:65], v[36:37] op_sel:[0,1,0] op_sel_hi:[1,1,1] neg_lo:[1,0,0] neg_hi:[1,0,0]
    v_pk_fma_f32 v[68:69], v[70:71], v[66:67], v[68:69] op_sel_hi:[1,0,1]
    v_cvt_pk_bf16_f32 v75, v68, v69
    v_pk_add_f32 v[38:39], v[38:39], v[64:65] op_sel_hi:[1,0] neg_lo:[0,1] neg_hi:[0,1]
    v_cvt_pk_bf16_f32 v67, v38, v39
    v_lshlrev_b32 v38, 16, v67
    v_and_b32 v39, 0xffff0000, v67
    v_pk_mul_f32 v[68:69], v[38:39], v[66:67] op_sel_hi:[1,0]
    v_pk_fma_f32 v[70:71], v[68:69], v[64:65], v[38:39] op_sel:[0,1,0] op_sel_hi:[1,1,1] neg_lo:[1,0,0] neg_hi:[1,0,0]
    v_pk_fma_f32 v[68:69], v[70:71], v[66:67], v[68:69] op_sel_hi:[1,0,1]
    v_cvt_pk_bf16_f32 v76, v68, v69
    v_pk_add_f32 v[40:41], v[40:41], v[64:65] op_sel_hi:[1,0] neg_lo:[0,1] neg_hi:[0,1]
    v_cvt_pk_bf16_f32 v67, v40, v41
    v_lshlrev_b32 v40, 16, v67
    v_and_b32 v41, 0xffff0000, v67
    v_pk_mul_f32 v[68:69], v[40:41], v[66:67] op_sel_hi:[1,0]
    v_pk_fma_f32 v[70:71], v[68:69], v[64:65], v[40:41] op_sel:[0,1,0] op_sel_hi:[1,1,1] neg_lo:[1,0,0] neg_hi:[1,0,0]
    v_pk_fma_f32 v[68:69], v[70:71], v[66:67], v[68:69] op_sel_hi:[1,0,1]
    v_cvt_pk_bf16_f32 v77, v68, v69
    v_pk_add_f32 v[42:43], v[42:43], v[64:65] op_sel_hi:[1,0] neg_lo:[0,1] neg_hi:[0,1]
    v_cvt_pk_bf16_f32 v67, v42, v43
    v_lshlrev_b32 v42, 16, v67
    v_and_b32 v43, 0xffff0000, v67
    v_pk_mul_f32 v[68:69], v[42:43], v[66:67] op_sel_hi:[1,0]
    v_pk_fma_f32 v[70:71], v[68:69], v[64:65], v[42:43] op_sel:[0,1,0] op_sel_hi:[1,1,1] neg_lo:[1,0,0] neg_hi:[1,0,0]
    v_pk_fma_f32 v[68:69], v[70:71], v[66:67], v[68:69] op_sel_hi:[1,0,1]
    v_cvt_pk_bf16_f32 v78, v68, v69
    v_pk_add_f32 v[44:45], v[44:45], v[64:65] op_sel_hi:[1,0] neg_lo:[0,1] neg_hi:[0,1]
    v_cvt_pk_bf16_f32 v67, v44, v45
    v_lshlrev_b32 v44, 16, v67
    v_and_b32 v45, 0xffff0000, v67
    v_pk_mul_f32 v[68:69], v[44:45], v[66:67] op_sel_hi:[1,0]
    v_pk_fma_f32 v[70:71], v[68:69], v[64:65], v[44:45] op_sel:[0,1,0] op_sel_hi:[1,1,1] neg_lo:[1,0,0] neg_hi:[1,0,0]
    v_pk_fma_f32 v[68:69], v[70:71], v[66:67], v[68:69] op_sel_hi:[1,0,1]
    v_cvt_pk_bf16_f32 v79, v68, v69
    v_pk_add_f32 v[46:47], v[46:47], v[64:65] op_sel_hi:[1,0] neg_lo:[0,1] neg_hi:[0,1]
    v_cvt_pk_bf16_f32 v67, v46, v47
    v_lshlrev_b32 v46, 16, v67
    v_and_b32 v47, 0xffff0000, v67
    v_pk_mul_f32 v[68:69], v[46:47], v[66:67] op_sel_hi:[1,0]
    v_pk_fma_f32 v[70:71], v[68:69], v[64:65], v[46:47] op_sel:[0,1,0] op_sel_hi:[1,1,1] neg_lo:[1,0,0] neg_hi:[1,0,0]
    v_pk_fma_f32 v[68:69], v[70:71], v[66:67], v[68:69] op_sel_hi:[1,0,1]
    v_cvt_pk_bf16_f32 v80, v68, v69
    v_pk_add_f32 v[48:49], v[48:49], v[64:65] op_sel_hi:[1,0] neg_lo:[0,1] neg_hi:[0,1]
    v_cvt_pk_bf16_f32 v67, v48, v49
    v_lshlrev_b32 v48, 16, v67
    v_and_b32 v49, 0xffff0000, v67
    v_pk_mul_f32 v[68:69], v[48:49], v[66:67] op_sel_hi:[1,0]
    v_pk_fma_f32 v[70:71], v[68:69], v[64:65], v[48:49] op_sel:[0,1,0] op_sel_hi:[1,1,1] neg_lo:[1,0,0] neg_hi:[1,0,0]
    v_pk_fma_f32 v[68:69], v[70:71], v[66:67], v[68:69] op_sel_hi:[1,0,1]
    v_cvt_pk_bf16_f32 v81, v68, v69
    v_pk_add_f32 v[50:51], v[50:51], v[64:65] op_sel_hi:[1,0] neg_lo:[0,1] neg_hi:[0,1]
    v_cvt_pk_bf16_f32 v67, v50, v51
    v_lshlrev_b32 v50, 16, v67
    v_and_b32 v51, 0xffff0000, v67
    v_pk_mul_f32 v[68:69], v[50:51], v[66:67] op_sel_hi:[1,0]
    v_pk_fma_f32 v[70:71], v[68:69], v[64:65], v[50:51] op_sel:[0,1,0] op_sel_hi:[1,1,1] neg_lo:[1,0,0] neg_hi:[1,0,0]
    v_pk_fma_f32 v[68:69], v[70:71], v[66:67], v[68:69] op_sel_hi:[1,0,1]
    v_cvt_pk_bf16_f32 v82, v68, v69
    v_pk_add_f32 v[52:53], v[52:53], v[64:65] op_sel_hi:[1,0] neg_lo:[0,1] neg_hi:[0,1]
    v_cvt_pk_bf16_f32 v67, v52, v53
    v_lshlrev_b32 v52, 16, v67
    v_and_b32 v53, 0xffff0000, v67
    v_pk_mul_f32 v[68:69], v[52:53], v[66:67] op_sel_hi:[1,0]
    v_pk_fma_f32 v[70:71], v[68:69], v[64:65], v[52:53] op_sel:[0,1,0] op_sel_hi:[1,1,1] neg_lo:[1,0,0] neg_hi:[1,0,0]
    v_pk_fma_f32 v[68:69], v[70:71], v[66:67], v[68:69] op_sel_hi:[1,0,1]
    v_cvt_pk_bf16_f32 v83, v68, v69
    v_pk_add_f32 v[54:55], v[54:55], v[64:65] op_sel_hi:[1,0] neg_lo:[0,1] neg_hi:[0,1]
    v_cvt_pk_bf16_f32 v67, v54, v55
    v_lshlrev_b32 v54, 16, v67
    v_and_b32 v55, 0xffff0000, v67
    v_pk_mul_f32 v[68:69], v[54:55], v[66:67] op_sel_hi:[1,0]
    v_pk_fma_f32 v[70:71], v[68:69], v[64:65], v[54:55] op_sel:[0,1,0] op_sel_hi:[1,1,1] neg_lo:[1,0,0] neg_hi:[1,0,0]
    v_pk_fma_f32 v[68:69], v[70:71], v[66:67], v[68:69] op_sel_hi:[1,0,1]
    v_cvt_pk_bf16_f32 v84, v68, v69
    v_pk_add_f32 v[56:57], v[56:57], v[64:65] op_sel_hi:[1,0] neg_lo:[0,1] neg_hi:[0,1]
    v_cvt_pk_bf16_f32 v67, v56, v57
    v_lshlrev_b32 v56, 16, v67
    v_and_b32 v57, 0xffff0000, v67
    v_pk_mul_f32 v[68:69], v[56:57], v[66:67] op_sel_hi:[1,0]
    v_pk_fma_f32 v[70:71], v[68:69], v[64:65], v[56:57] op_sel:[0,1,0] op_sel_hi:[1,1,1] neg_lo:[1,0,0] neg_hi:[1,0,0]
    v_pk_fma_f32 v[68:69], v[70:71], v[66:67], v[68:69] op_sel_hi:[1,0,1]
    v_cvt_pk_bf16_f32 v85, v68, v69
    ds_write_b16 v5, v72 offset:0
    ds_write_b16 v6, v10 offset:0
    ds_write_b16_d16_hi v5, v72 offset:36
    ds_write_b16_d16_hi v6, v10 offset:36
    ds_write_b16 v5, v73 offset:72
    ds_write_b16 v6, v11 offset:72
    ds_write_b16_d16_hi v5, v73 offset:108
    ds_write_b16_d16_hi v6, v11 offset:108
    ds_write_b16 v5, v74 offset:2304
    ds_write_b16 v6, v12 offset:2304
    ds_write_b16_d16_hi v5, v74 offset:2340
    ds_write_b16_d16_hi v6, v12 offset:2340
    ds_write_b16 v5, v75 offset:2376
    ds_write_b16 v6, v13 offset:2376
    ds_write_b16_d16_hi v5, v75 offset:2412
    ds_write_b16_d16_hi v6, v13 offset:2412
    ds_write_b16 v5, v76 offset:4608
    ds_write_b16 v6, v14 offset:4608
    ds_write_b16_d16_hi v5, v76 offset:4644
    ds_write_b16_d16_hi v6, v14 offset:4644
    ds_write_b16 v5, v77 offset:4680
    ds_write_b16 v6, v15 offset:4680
    ds_write_b16_d16_hi v5, v77 offset:4716
    ds_write_b16_d16_hi v6, v15 offset:4716
    ds_write_b16 v5, v78 offset:6912
    ds_write_b16 v6, v16 offset:6912
    ds_write_b16_d16_hi v5, v78 offset:6948
    ds_write_b16_d16_hi v6, v16 offset:6948
    ds_write_b16 v5, v79 offset:6984
    ds_write_b16 v6, v17 offset:6984
    ds_write_b16_d16_hi v5, v79 offset:7020
    ds_write_b16_d16_hi v6, v17 offset:7020
    ds_write_b16 v5, v80 offset:9216
    ds_write_b16 v6, v18 offset:9216
    ds_write_b16_d16_hi v5, v80 offset:9252
    ds_write_b16_d16_hi v6, v18 offset:9252
    ds_write_b16 v5, v81 offset:9288
    ds_write_b16 v6, v19 offset:9288
    ds_write_b16_d16_hi v5, v81 offset:9324
    ds_write_b16_d16_hi v6, v19 offset:9324
    ds_write_b16 v5, v82 offset:11520
    ds_write_b16 v6, v20 offset:11520
    ds_write_b16_d16_hi v5, v82 offset:11556
    ds_write_b16_d16_hi v6, v20 offset:11556
    ds_write_b16 v5, v83 offset:11592
    ds_write_b16 v6, v21 offset:11592
    ds_write_b16_d16_hi v5, v83 offset:11628
    ds_write_b16_d16_hi v6, v21 offset:11628
    ds_write_b16 v5, v84 offset:13824
    ds_write_b16 v6, v22 offset:13824
    ds_write_b16_d16_hi v5, v84 offset:13860
    ds_write_b16_d16_hi v6, v22 offset:13860
    ds_write_b16 v5, v85 offset:13896
    ds_write_b16 v6, v23 offset:13896
    ds_write_b16_d16_hi v5, v85 offset:13932
    ds_write_b16_d16_hi v6, v23 offset:13932
    s_waitcnt lgkmcnt(0)
    s_barrier
    v_and_b32 v1, 127, v0
    v_lshrrev_b32 v2, 7, v0
    v_lshrrev_b32 v3, 1, v1
    v_and_b32 v4, 1, v1
    v_mul_u32_u24 v5, 36, v3
    v_lshl_add_u32 v5, v4, 4, v5
    v_mul_u32_u24 v6, 16128, v2
    v_add_u32 v5, v5, v6
    v_lshlrev_b32 v7, 12, v3
    v_lshl_add_u32 v7, v4, 4, v7
    s_nop 0
    v_readfirstlane_b32 s22, v2
    s_lshl_b32 s23, s20, 1
    s_sub_u32 s24, 4064, s23
    s_add_u32 s25, s23, 2097152
    s_cmp_eq_u32 s22, 0
    s_cselect_b32 s24, s24, s25
    ds_read_b32 v10, v5 offset:0
    ds_read_b32 v11, v5 offset:4
    ds_read_b32 v12, v5 offset:8
    ds_read_b32 v13, v5 offset:12
    ds_read_b32 v14, v5 offset:2304
    ds_read_b32 v15, v5 offset:2308
    ds_read_b32 v16, v5 offset:2312
    ds_read_b32 v17, v5 offset:2316
    ds_read_b32 v18, v5 offset:4608
    ds_read_b32 v19, v5 offset:4612
    ds_read_b32 v20, v5 offset:4616
    ds_read_b32 v21, v5 offset:4620
    ds_read_b32 v22, v5 offset:6912
    ds_read_b32 v23, v5 offset:6916
    ds_read_b32 v24, v5 offset:6920
    ds_read_b32 v25, v5 offset:6924
    ds_read_b32 v26, v5 offset:9216
    ds_read_b32 v27, v5 offset:9220
    ds_read_b32 v28, v5 offset:9224
    ds_read_b32 v29, v5 offset:9228
    ds_read_b32 v30, v5 offset:11520
    ds_read_b32 v31, v5 offset:11524
    ds_read_b32 v32, v5 offset:11528
    ds_read_b32 v33, v5 offset:11532
    ds_read_b32 v34, v5 offset:13824
    ds_read_b32 v35, v5 offset:13828
    ds_read_b32 v36, v5 offset:13832
    ds_read_b32 v37, v5 offset:13836
    s_waitcnt lgkmcnt(15)
    buffer_store_dwordx4 v[10:13], v7, s[12:15], s24 offen
    s_add_u32 s24, s24, 262144
    s_waitcnt lgkmcnt(15)
    buffer_store_dwordx4 v[14:17], v7, s[12:15], s24 offen
    s_add_u32 s24, s24, 262144
    s_waitcnt lgkmcnt(15)
    buffer_store_dwordx4 v[18:21], v7, s[12:15], s24 offen
    s_add_u32 s24, s24, 262144
    s_waitcnt lgkmcnt(12)
    buffer_store_dwordx4 v[22:25], v7, s[12:15], s24 offen
    s_add_u32 s24, s24, 262144
    s_waitcnt lgkmcnt(8)
    buffer_store_dwordx4 v[26:29], v7, s[12:15], s24 offen
    s_add_u32 s24, s24, 262144
    s_waitcnt lgkmcnt(4)
    buffer_store_dwordx4 v[30:33], v7, s[12:15], s24 offen
    s_add_u32 s24, s24, 262144
    s_waitcnt lgkmcnt(0)
    buffer_store_dwordx4 v[34:37], v7, s[12:15], s24 offen
    s_add_u32 s24, s24, 262144
    s_endpgm
L_k1_kgen:
    s_load_dwordx4 s[4:7], s[0:1], 8
    s_load_dwordx4 s[8:11], s[0:1], 24
    s_load_dwordx4 s[12:15], s[0:1], 40
    s_load_dwordx2 s[16:17], s[0:1], 56
    s_load_dwordx2 s[18:19], s[0:1], 120
    s_load_dwordx2 s[30:31], s[0:1], 64
    s_lshl_b32 s3, s2, 9
    v_lshl_add_u32 v1, v0, 1, s3
    s_lshl_b32 s3, s2, 1
    v_mov_b32 v2, s3
    s_waitcnt lgkmcnt(0)
    global_load_ushort v10, v1, s[4:5]
    global_load_ushort v11, v1, s[6:7]
    global_load_ushort v12, v1, s[8:9]
    global_load_ushort v13, v1, s[10:11]
    global_load_ushort v14, v1, s[12:13]
    global_load_ushort v15, v1, s[14:15]
    global_load_ushort v16, v2, s[16:17]
    s_mov_b32 s20, s18
    s_and_b32 s21, s19, 0xffff
    s_mov_b32 s22, 0x1900000
    s_mov_b32 s23, 0x20000
    v_and_b32 v3, 63, v0
    v_lshrrev_b32 v4, 6, v0
    v_mul_u32_u24 v5, 13312, v4
    v_lshl_add_u32 v6, v3, 2, v5
    v_xor_b32 v100, 0, v6
    v_xor_b32 v101, 16, v6
    v_xor_b32 v102, 32, v6
    v_xor_b32 v103, 48, v6
    v_xor_b32 v104, 64, v6
    v_xor_b32 v105, 80, v6
    v_xor_b32 v106, 96, v6
    v_xor_b32 v107, 112, v6
    v_xor_b32 v108, 128, v6
    v_xor_b32 v109, 144, v6
    v_xor_b32 v110, 160, v6
    v_xor_b32 v111, 176, v6
    v_xor_b32 v112, 192, v6
    v_xor_b32 v113, 208, v6
    v_xor_b32 v114, 224, v6
    v_xor_b32 v115, 240, v6
    s_waitcnt vmcnt(0)
    v_lshlrev_b32 v10, 16, v10
    v_lshlrev_b32 v11, 16, v11
    v_lshlrev_b32 v12, 16, v12
    v_lshlrev_b32 v13, 16, v13
    v_lshlrev_b32 v14, 16, v14
    v_lshlrev_b32 v15, 16, v15
    v_lshlrev_b32 v16, 16, v16
    v_mul_f32 v16, 0x3fb8aa3b, v16
    v_exp_f32 v16, v16
    s_nop 0
    v_cvt_pk_bf16_f32 v16, v16, v16
    v_and_b32 v16, 0xffff0000, v16
    v_mul_f32 v17, v16, v10
    v_mul_f32 v18, v16, v11
    v_mul_f32 v17, 0x3fb8aa3b, v17
    v_mul_f32 v18, 0x3e22f983, v18
    v_mul_f32 v12, v16, v12
    v_mul_f32 v13, v16, v13
    v_pk_mul_f32 v[20:21], v[14:15], v[12:13] op_sel:[0,0] op_sel_hi:[0,1]
    v_pk_fma_f32 v[20:21], v[14:15], v[12:13], v[20:21] op_sel:[1,1,0] op_sel_hi:[1,0,1] neg_lo:[1,0,0]
    v_mul_f32 v8, 0x3f800000, v17
    v_mul_f32 v9, 0x3f800000, v18
    v_exp_f32 v8, v8
    v_fract_f32 v9, v9
    v_cos_f32 v22, v9
    v_sin_f32 v23, v9
    s_nop 0
    v_mul_f32 v22, v22, v8
    v_mul_f32 v23, v23, v8
    v_mul_f32 v8, 0x41000000, v17
    v_mul_f32 v9, 0x41000000, v18
    v_exp_f32 v8, v8
    v_fract_f32 v9, v9
    v_cos_f32 v24, v9
    v_sin_f32 v25, v9
    s_nop 0
    v_mul_f32 v24, v24, v8
    v_mul_f32 v25, v25, v8
    v_mul_f32 v8, 0x43800000, v17
    v_mul_f32 v9, 0x43800000, v18
    v_exp_f32 v8, v8
    v_fract_f32 v9, v9
    v_cos_f32 v30, v9
    v_sin_f32 v31, v9
    s_nop 0
    v_mul_f32 v30, v30, v8
    v_mul_f32 v31, v31, v8
    v_mul_f32 v8, 0x44000000, v17
    v_mul_f32 v9, 0x44000000, v18
    v_exp_f32 v8, v8
    v_fract_f32 v9, v9
    v_cos_f32 v32, v9
    v_sin_f32 v33, v9
    s_nop 0
    v_mul_f32 v32, v32, v8
    v_mul_f32 v33, v33, v8
    v_mul_f32 v8, 0x44800000, v17
    v_mul_f32 v9, 0x44800000, v18
    v_exp_f32 v8, v8
    v_fract_f32 v9, v9
    v_cos_f32 v36, v9
    v_sin_f32 v37, v9
    s_nop 0
    v_mul_f32 v36, v36, v8
    v_mul_f32 v37, v37, v8
    v_mul_f32 v8, 0x45000000, v17
    v_mul_f32 v9, 0x45000000, v18
    v_exp_f32 v8, v8
    v_fract_f32 v9, v9
    v_cos_f32 v44, v9
    v_sin_f32 v45, v9
    s_nop 0
    v_mul_f32 v44, v44, v8
    v_mul_f32 v45, v45, v8
    v_pk_mul_f32 v[34:35], v[30:31], v[32:33] op_sel:[0,0] op_sel_hi:[0,1]
    v_pk_fma_f32 v[34:35], v[30:31], v[32:33], v[34:35] op_sel:[1,1,0] op_sel_hi:[1,0,1] neg_lo:[1,0,0]
    v_pk_mul_f32 v[38:39], v[36:37], v[30:31] op_sel:[0,0] op_sel_hi:[0,1]
    v_pk_fma_f32 v[38:39], v[36:37], v[30:31], v[38:39] op_sel:[1,1,0] op_sel_hi:[1,0,1] neg_lo:[1,0,0]
    v_pk_mul_f32 v[40:41], v[36:37], v[32:33] op_sel:[0,0] op_sel_hi:[0,1]
    v_pk_fma_f32 v[40:41], v[36:37], v[32:33], v[40:41] op_sel:[1,1,0] op_sel_hi:[1,0,1] neg_lo:[1,0,0]
    v_pk_mul_f32 v[42:43], v[36:37], v[34:35] op_sel:[0,0] op_sel_hi:[0,1]
    v_pk_fma_f32 v[42:43], v[36:37], v[34:35], v[42:43] op_sel:[1,1,0] op_sel_hi:[1,0,1] neg_lo:[1,0,0]
    v_mov_b32 v50, v20
    v_mov_b32 v51, v21
    v_mov_b32 v70, 0x3f80
    v_lshlrev_b32 v71, 2, v3
    ds_write_b32 v71, v70 offset:53248
    v_cvt_pk_bf16_f32 v6, v24, v25
    ds_write_b32 v105, v6 offset:5376
    v_cvt_pk_bf16_f32 v7, v50, -v51
    ds_write_b32 v100, v7 offset:0
    v_pk_mul_f32 v[70:71], v[24:25], v[24:25] op_sel:[0,0] op_sel_hi:[0,1]
    v_pk_fma_f32 v[70:71], v[24:25], v[24:25], v[70:71] op_sel:[1,1,0] op_sel_hi:[1,0,1] neg_lo:[1,0,0]
    v_cvt_pk_bf16_f32 v6, v70, v71
    ds_write_b32 v106, v6 offset:5632
    v_pk_mul_f32 v[52:53], v[50:51], v[22:23] op_sel:[0,0] op_sel_hi:[0,1]
    v_pk_fma_f32 v[52:53], v[50:51], v[22:23], v[52:53] op_sel:[1,1,0] op_sel_hi:[1,0,1] neg_lo:[1,0,0]
    v_cvt_pk_bf16_f32 v7, v52, -v53
    ds_write_b32 v101, v7 offset:256
    v_pk_mul_f32 v[72:73], v[70:71], v[24:25] op_sel:[0,0] op_sel_hi:[0,1]
    v_pk_fma_f32 v[72:73], v[70:71], v[24:25], v[72:73] op_sel:[1,1,0] op_sel_hi:[1,0,1] neg_lo:[1,0,0]
    v_cvt_pk_bf16_f32 v6, v72, v73
    ds_write_b32 v107, v6 offset:5888
    v_pk_mul_f32 v[54:55], v[52:53], v[22:23] op_sel:[0,0] op_sel_hi:[0,1]
    v_pk_fma_f32 v[54:55], v[52:53], v[22:23], v[54:55] op_sel:[1,1,0] op_sel_hi:[1,0,1] neg_lo:[1,0,0]
    v_cvt_pk_bf16_f32 v7, v54, -v55
    ds_write_b32 v102, v7 offset:512
    v_pk_mul_f32 v[70:71], v[72:73], v[24:25] op_sel:[0,0] op_sel_hi:[0,1]
    v_pk_fma_f32 v[70:71], v[72:73], v[24:25], v[70:71] op_sel:[1,1,0] op_sel_hi:[1,0,1] neg_lo:[1,0,0]
    v_cvt_pk_bf16_f32 v6, v70, v71
    ds_write_b32 v108, v6 offset:6144
    v_pk_mul_f32 v[56:57], v[54:55], v[22:23] op_sel:[0,0] op_sel_hi:[0,1]
    v_pk_fma_f32 v[56:57], v[54:55], v[22:23], v[56:57] op_sel:[1,1,0] op_sel_hi:[1,0,1] neg_lo:[1,0,0]
    v_cvt_pk_bf16_f32 v7, v56, -v57
    ds_write_b32 v103, v7 offset:768
    v_pk_mul_f32 v[72:73], v[70:71], v[24:25] op_sel:[0,0] op_sel_hi:[0,1]
    v_pk_fma_f32 v[72:73], v[70:71], v[24:25], v[72:73] op_sel:[1,1,0] op_sel_hi:[1,0,1] neg_lo:[1,0,0]
    v_cvt_pk_bf16_f32 v6, v72, v73
    ds_write_b32 v109, v6 offset:6400
    v_pk_mul_f32 v[58:59], v[56:57], v[22:23] op_sel:[0,0] op_sel_hi:[0,1]
    v_pk_fma_f32 v[58:59], v[56:57], v[22:23], v[58:59] op_sel:[1,1,0] op_sel_hi:[1,0,1] neg_lo:[1,0,0]
    v_cvt_pk_bf16_f32 v7, v58, -v59
    ds_write_b32 v104, v7 offset:1024
    v_pk_mul_f32 v[70:71], v[72:73], v[24:25] op_sel:[0,0] op_sel_hi:[0,1]
    v_pk_fma_f32 v[70:71], v[72:73], v[24:25], v[70:71] op_sel:[1,1,0] op_sel_hi:[1,0,1] neg_lo:[1,0,0]
    v_cvt_pk_bf16_f32 v6, v70, v71
    ds_write_b32 v110, v6 offset:6656
    v_pk_mul_f32 v[60:61], v[58:59], v[22:23] op_sel:[0,0] op_sel_hi:[0,1]
    v_pk_fma_f32 v[60:61], v[58:59], v[22:23], v[60:61] op_sel:[1,1,0] op_sel_hi:[1,0,1] neg_lo:[1,0,0]
    v_cvt_pk_bf16_f32 v7, v60, -v61
    ds_write_b32 v105, v7 offset:1280
    v_pk_mul_f32 v[72:73], v[70:71], v[24:25] op_sel:[0,0] op_sel_hi:[0,1]
    v_pk_fma_f32 v[72:73], v[70:71], v[24:25], v[72:73] op_sel:[1,1,0] op_sel_hi:[1,0,1] neg_lo:[1,0,0]
    v_cvt_pk_bf16_f32 v6, v72, v73
    ds_write_b32 v111, v6 offset:6912
    v_pk_mul_f32 v[62:63], v[60:61], v[22:23] op_sel:[0,0] op_sel_hi:[0,1]
    v_pk_fma_f32 v[62:63], v[60:61], v[22:23], v[62:63] op_sel:[1,1,0] op_sel_hi:[1,0,1] neg_lo:[1,0,0]
    v_cvt_pk_bf16_f32 v7, v62, -v63
    ds_write_b32 v106, v7 offset:1536
    v_pk_mul_f32 v[70:71], v[72:73], v[24:25] op_sel:[0,0] op_sel_hi:[0,1]
    v_pk_fma_f32 v[70:71], v[72:73], v[24:25], v[70:71] op_sel:[1,1,0] op_sel_hi:[1,0,1] neg_lo:[1,0,0]
    v_cvt_pk_bf16_f32 v6, v70, v71
    ds_write_b32 v112, v6 offset:7168
    v_pk_mul_f32 v[64:65], v[62:63], v[22:23] op_sel:[0,0] op_sel_hi:[0,1]
    v_pk_fma_f32 v[64:65], v[62:63], v[22:23], v[64:65] op_sel:[1,1,0] op_sel_hi:[1,0,1] neg_lo:[1,0,0]
    v_cvt_pk_bf16_f32 v7, v64, -v65
    ds_write_b32 v107, v7 offset:1792
    v_pk_mul_f32 v[72:73], v[70:71], v[24:25] op_sel:[0,0] op_sel_hi:[0,1]
    v_pk_fma_f32 v[72:73], v[70:71], v[24:25], v[72:73] op_sel:[1,1,0] op_sel_hi:[1,0,1] neg_lo:[1,0,0]
    v_cvt_pk_bf16_f32 v6, v72, v73
    ds_write_b32 v113, v6 offset:7424
    v_pk_mul_f32 v[74:75], v[30:31], v[50:51] op_sel:[0,0] op_sel_hi:[0,1]
    v_pk_fma_f32 v[74:75], v[30:31], v[50:51], v[74:75] op_sel:[1,1,0] op_sel_hi:[1,0,1] neg_lo:[1,0,0]
    v_cvt_pk_bf16_f32 v7, v74, -v75
    ds_write_b32 v108, v7 offset:2048
    v_pk_mul_f32 v[70:71], v[72:73], v[24:25] op_sel:[0,0] op_sel_hi:[0,1]
    v_pk_fma_f32 v[70:71], v[72:73], v[24:25], v[70:71] op_sel:[1,1,0] op_sel_hi:[1,0,1] neg_lo:[1,0,0]
    v_cvt_pk_bf16_f32 v6, v70, v71
    ds_write_b32 v114, v6 offset:7680
    v_pk_mul_f32 v[74:75], v[30:31], v[54:55] op_sel:[0,0] op_sel_hi:[0,1]
    v_pk_fma_f32 v[74:75], v[30:31], v[54:55], v[74:75] op_sel:[1,1,0] op_sel_hi:[1,0,1] neg_lo:[1,0,0]
    v_cvt_pk_bf16_f32 v7, v74, -v75
    ds_write_b32 v109, v7 offset:2304
    v_pk_mul_f32 v[72:73], v[70:71], v[24:25] op_sel:[0,0] op_sel_hi:[0,1]
    v_pk_fma_f32 v[72:73], v[70:71], v[24:25], v[72:73] op_sel:[1,1,0] op_sel_hi:[1,0,1] neg_lo:[1,0,0]
    v_cvt_pk_bf16_f32 v6, v72, v73
    ds_write_b32 v115, v6 offset:7936
    v_pk_mul_f32 v[74:75], v[30:31], v[58:59] op_sel:[0,0] op_sel_hi:[0,1]
    v_pk_fma_f32 v[74:75], v[30:31], v[58:59], v[74:75] op_sel:[1,1,0] op_sel_hi:[1,0,1] neg_lo:[1,0,0]
    v_cvt_pk_bf16_f32 v7, v74, -v75
    ds_write_b32 v110, v7 offset:2560
    v_pk_mul_f32 v[70:71], v[72:73], v[24:25] op_sel:[0,0] op_sel_hi:[0,1]
    v_pk_fma_f32 v[70:71], v[72:73], v[24:25], v[70:71] op_sel:[1,1,0] op_sel_hi:[1,0,1] neg_lo:[1,0,0]
    v_cvt_pk_bf16_f32 v6, v70, v71
    ds_write_b32 v100, v6 offset:8192
    v_pk_mul_f32 v[74:75], v[30:31], v[62:63] op_sel:[0,0] op_sel_hi:[0,1]
    v_pk_fma_f32 v[74:75], v[30:31], v[62:63], v[74:75] op_sel:[1,1,0] op_sel_hi:[1,0,1] neg_lo:[1,0,0]
    v_cvt_pk_bf16_f32 v7, v74, -v75
    ds_write_b32 v111, v7 offset:2816
    v_pk_mul_f32 v[72:73], v[70:71], v[24:25] op_sel:[0,0] op_sel_hi:[0,1]
    v_pk_fma_f32 v[72:73], v[70:71], v[24:25], v[72:73] op_sel:[1,1,0] op_sel_hi:[1,0,1] neg_lo:[1,0,0]
    v_cvt_pk_bf16_f32 v6, v72, v73
    ds_write_b32 v101, v6 offset:8448
    v_pk_mul_f32 v[74:75], v[32:33], v[50:51] op_sel:[0,0] op_sel_hi:[0,1]
    v_pk_fma_f32 v[74:75], v[32:33], v[50:51], v[74:75] op_sel:[1,1,0] op_sel_hi:[1,0,1] neg_lo:[1,0,0]
    v_cvt_pk_bf16_f32 v7, v74, -v75
    ds_write_b32 v112, v7 offset:3072
    v_pk_mul_f32 v[70:71], v[72:73], v[24:25] op_sel:[0,0] op_sel_hi:[0,1]
    v_pk_fma_f32 v[70:71], v[72:73], v[24:25], v[70:71] op_sel:[1,1,0] op_sel_hi:[1,0,1] neg_lo:[1,0,0]
    v_cvt_pk_bf16_f32 v6, v70, v71
    ds_write_b32 v102, v6 offset:8704
    v_pk_mul_f32 v[74:75], v[32:33], v[58:59] op_sel:[0,0] op_sel_hi:[0,1]
    v_pk_fma_f32 v[74:75], v[32:33], v[58:59], v[74:75] op_sel:[1,1,0] op_sel_hi:[1,0,1] neg_lo:[1,0,0]
    v_cvt_pk_bf16_f32 v7, v74, -v75
    ds_write_b32 v113, v7 offset:3328
    v_pk_mul_f32 v[72:73], v[70:71], v[24:25] op_sel:[0,0] op_sel_hi:[0,1]
    v_pk_fma_f32 v[72:73], v[70:71], v[24:25], v[72:73] op_sel:[1,1,0] op_sel_hi:[1,0,1] neg_lo:[1,0,0]
    v_cvt_pk_bf16_f32 v6, v72, v73
    ds_write_b32 v103, v6 offset:8960
    v_pk_mul_f32 v[74:75], v[34:35], v[50:51] op_sel:[0,0] op_sel_hi:[0,1]
    v_pk_fma_f32 v[74:75], v[34:35], v[50:51], v[74:75] op_sel:[1,1,0] op_sel_hi:[1,0,1] neg_lo:[1,0,0]
    v_cvt_pk_bf16_f32 v7, v74, -v75
    ds_write_b32 v114, v7 offset:3584
    v_pk_mul_f32 v[70:71], v[72:73], v[24:25] op_sel:[0,0] op_sel_hi:[0,1]
    v_pk_fma_f32 v[70:71], v[72:73], v[24:25], v[70:71] op_sel:[1,1,0] op_sel_hi:[1,0,1] neg_lo:[1,0,0]
    v_cvt_pk_bf16_f32 v6, v70, v71
    ds_write_b32 v104, v6 offset:9216
    v_pk_mul_f32 v[74:75], v[34:35], v[58:59] op_sel:[0,0] op_sel_hi:[0,1]
    v_pk_fma_f32 v[74:75], v[34:35], v[58:59], v[74:75] op_sel:[1,1,0] op_sel_hi:[1,0,1] neg_lo:[1,0,0]
    v_cvt_pk_bf16_f32 v7, v74, -v75
    ds_write_b32 v115, v7 offset:3840
    v_pk_mul_f32 v[72:73], v[70:71], v[24:25] op_sel:[0,0] op_sel_hi:[0,1]
    v_pk_fma_f32 v[72:73], v[70:71], v[24:25], v[72:73] op_sel:[1,1,0] op_sel_hi:[1,0,1] neg_lo:[1,0,0]
    v_cvt_pk_bf16_f32 v6, v72, v73
    ds_write_b32 v105, v6 offset:9472
    v_pk_mul_f32 v[74:75], v[36:37], v[50:51] op_sel:[0,0] op_sel_hi:[0,1]
    v_pk_fma_f32 v[74:75], v[36:37], v[50:51], v[74:75] op_sel:[1,1,0] op_sel_hi:[1,0,1] neg_lo:[1,0,0]
    v_cvt_pk_bf16_f32 v7, v74, -v75
    ds_write_b32 v100, v7 offset:4096
    v_pk_mul_f32 v[70:71], v[72:73], v[24:25] op_sel:[0,0] op_sel_hi:[0,1]
    v_pk_fma_f32 v[70:71], v[72:73], v[24:25], v[70:71] op_sel:[1,1,0] op_sel_hi:[1,0,1] neg_lo:[1,0,0]
    v_cvt_pk_bf16_f32 v6, v70, v71
    ds_write_b32 v106, v6 offset:9728
    v_pk_mul_f32 v[74:75], v[38:39], v[50:51] op_sel:[0,0] op_sel_hi:[0,1]
    v_pk_fma_f32 v[74:75], v[38:39], v[50:51], v[74:75] op_sel:[1,1,0] op_sel_hi:[1,0,1] neg_lo:[1,0,0]
    v_cvt_pk_bf16_f32 v7, v74, -v75
    ds_write_b32 v101, v7 offset:4352
    v_pk_mul_f32 v[72:73], v[70:71], v[24:25] op_sel:[0,0] op_sel_hi:[0,1]
    v_pk_fma_f32 v[72:73], v[70:71], v[24:25], v[72:73] op_sel:[1,1,0] op_sel_hi:[1,0,1] neg_lo:[1,0,0]
    v_cvt_pk_bf16_f32 v6, v72, v73
    ds_write_b32 v107, v6 offset:9984
    v_pk_mul_f32 v[74:75], v[40:41], v[50:51] op_sel:[0,0] op_sel_hi:[0,1]
    v_pk_fma_f32 v[74:75], v[40:41], v[50:51], v[74:75] op_sel:[1,1,0] op_sel_hi:[1,0,1] neg_lo:[1,0,0]
    v_cvt_pk_bf16_f32 v7, v74, -v75
    ds_write_b32 v102, v7 offset:4608
    v_pk_mul_f32 v[70:71], v[72:73], v[24:25] op_sel:[0,0] op_sel_hi:[0,1]
    v_pk_fma_f32 v[70:71], v[72:73], v[24:25], v[70:71] op_sel:[1,1,0] op_sel_hi:[1,0,1] neg_lo:[1,0,0]
    v_cvt_pk_bf16_f32 v6, v70, v71
    ds_write_b32 v108, v6 offset:10240
    v_pk_mul_f32 v[74:75], v[42:43], v[50:51] op_sel:[0,0] op_sel_hi:[0,1]
    v_pk_fma_f32 v[74:75], v[42:43], v[50:51], v[74:75] op_sel:[1,1,0] op_sel_hi:[1,0,1] neg_lo:[1,0,0]
    v_cvt_pk_bf16_f32 v7, v74, -v75
    ds_write_b32 v103, v7 offset:4864
    v_pk_mul_f32 v[72:73], v[70:71], v[24:25] op_sel:[0,0] op_sel_hi:[0,1]
    v_pk_fma_f32 v[72:73], v[70:71], v[24:25], v[72:73] op_sel:[1,1,0] op_sel_hi:[1,0,1] neg_lo:[1,0,0]
    v_cvt_pk_bf16_f32 v6, v72, v73
    ds_write_b32 v109, v6 offset:10496
    v_pk_mul_f32 v[74:75], v[44:45], v[50:51] op_sel:[0,0] op_sel_hi:[0,1]
    v_pk_fma_f32 v[74:75], v[44:45], v[50:51], v[74:75] op_sel:[1,1,0] op_sel_hi:[1,0,1] neg_lo:[1,0,0]
    v_cvt_pk_bf16_f32 v7, v74, -v75
    ds_write_b32 v104, v7 offset:5120
    v_pk_mul_f32 v[70:71], v[72:73], v[24:25] op_sel:[0,0] op_sel_hi:[0,1]
    v_pk_fma_f32 v[70:71], v[72:73], v[24:25], v[70:71] op_sel:[1,1,0] op_sel_hi:[1,0,1] neg_lo:[1,0,0]
    v_cvt_pk_bf16_f32 v6, v70, v71
    ds_write_b32 v110, v6 offset:10752
    v_pk_mul_f32 v[72:73], v[70:71], v[24:25] op_sel:[0,0] op_sel_hi:[0,1]
    v_pk_fma_f32 v[72:73], v[70:71], v[24:25], v[72:73] op_sel:[1,1,0] op_sel_hi:[1,0,1] neg_lo:[1,0,0]
    v_cvt_pk_bf16_f32 v6, v72, v73
    ds_write_b32 v111, v6 offset:11008
    v_pk_mul_f32 v[70:71], v[72:73], v[24:25] op_sel:[0,0] op_sel_hi:[0,1]
    v_pk_fma_f32 v[70:71], v[72:73], v[24:25], v[70:71] op_sel:[1,1,0] op_sel_hi:[1,0,1] neg_lo:[1,0,0]
    v_cvt_pk_bf16_f32 v6, v70, v71
    ds_write_b32 v112, v6 offset:11264
    v_pk_mul_f32 v[72:73], v[70:71], v[24:25] op_sel:[0,0] op_sel_hi:[0,1]
    v_pk_fma_f32 v[72:73], v[70:71], v[24:25], v[72:73] op_sel:[1,1,0] op_sel_hi:[1,0,1] neg_lo:[1,0,0]
    v_cvt_pk_bf16_f32 v6, v72, v73
    ds_write_b32 v113, v6 offset:11520
    v_pk_mul_f32 v[70:71], v[72:73], v[24:25] op_sel:[0,0] op_sel_hi:[0,1]
    v_pk_fma_f32 v[70:71], v[72:73], v[24:25], v[70:71] op_sel:[1,1,0] op_sel_hi:[1,0,1] neg_lo:[1,0,0]
    v_cvt_pk_bf16_f32 v6, v70, v71
    ds_write_b32 v114, v6 offset:11776
    v_pk_mul_f32 v[72:73], v[70:71], v[24:25] op_sel:[0,0] op_sel_hi:[0,1]
    v_pk_fma_f32 v[72:73], v[70:71], v[24:25], v[72:73] op_sel:[1,1,0] op_sel_hi:[1,0,1] neg_lo:[1,0,0]
    v_cvt_pk_bf16_f32 v6, v72, v73
    ds_write_b32 v115, v6 offset:12032
    v_pk_mul_f32 v[70:71], v[72:73], v[24:25] op_sel:[0,0] op_sel_hi:[0,1]
    v_pk_fma_f32 v[70:71], v[72:73], v[24:25], v[70:71] op_sel:[1,1,0] op_sel_hi:[1,0,1] neg_lo:[1,0,0]
    v_cvt_pk_bf16_f32 v6, v70, v71
    ds_write_b32 v100, v6 offset:12288
    v_pk_mul_f32 v[72:73], v[70:71], v[24:25] op_sel:[0,0] op_sel_hi:[0,1]
    v_pk_fma_f32 v[72:73], v[70:71], v[24:25], v[72:73] op_sel:[1,1,0] op_sel_hi:[1,0,1] neg_lo:[1,0,0]
    v_cvt_pk_bf16_f32 v6, v72, v73
    ds_write_b32 v101, v6 offset:12544
    v_pk_mul_f32 v[70:71], v[72:73], v[24:25] op_sel:[0,0] op_sel_hi:[0,1]
    v_pk_fma_f32 v[70:71], v[72:73], v[24:25], v[70:71] op_sel:[1,1,0] op_sel_hi:[1,0,1] neg_lo:[1,0,0]
    v_cvt_pk_bf16_f32 v6, v70, v71
    ds_write_b32 v102, v6 offset:12800
    v_pk_mul_f32 v[72:73], v[70:71], v[24:25] op_sel:[0,0] op_sel_hi:[0,1]
    v_pk_fma_f32 v[72:73], v[70:71], v[24:25], v[72:73] op_sel:[1,1,0] op_sel_hi:[1,0,1] neg_lo:[1,0,0]
    v_cvt_pk_bf16_f32 v6, v72, v73
    ds_write_b32 v103, v6 offset:13056
    v_and_b32 v6, 31, v3
    v_lshrrev_b32 v7, 5, v3
    v_and_b32 v8, 15, v6
    v_xor_b32 v8, v8, v7
    v_lshlrev_b32 v8, 4, v8
    v_lshl_add_u32 v8, v6, 8, v8
    v_add_u32 v8, v8, v5
    v_add_u32 v9, 20, v6
    v_and_b32 v10, 15, v9
    v_xor_b32 v10, v10, v7
    v_lshlrev_b32 v10, 4, v10
    v_lshl_add_u32 v10, v9, 8, v10
    v_add_u32 v10, v10, v5
    v_cmp_eq_u32 vcc, 0, v6
    v_mov_b32 v9, 53248
    s_nop 0
    v_cndmask_b32 v10, v10, v9, vcc
    s_waitcnt lgkmcnt(0)
    v_xor_b32 v11, 0, v8
    v_xor_b32 v12, 0, v10
    ds_read_b128 v[16:19], v11
    ds_read_b128 v[20:23], v12
    v_xor_b32 v11, 32, v8
    v_xor_b32 v12, 32, v10
    ds_read_b128 v[24:27], v11
    ds_read_b128 v[28:31], v12
    v_xor_b32 v11, 64, v8
    v_xor_b32 v12, 64, v10
    ds_read_b128 v[32:35], v11
    ds_read_b128 v[36:39], v12
    v_xor_b32 v11, 96, v8
    v_xor_b32 v12, 96, v10
    ds_read_b128 v[40:43], v11
    ds_read_b128 v[44:47], v12
    v_xor_b32 v11, 128, v8
    v_xor_b32 v12, 128, v10
    ds_read_b128 v[48:51], v11
    ds_read_b128 v[52:55], v12
    v_xor_b32 v11, 160, v8
    v_xor_b32 v12, 160, v10
    ds_read_b128 v[56:59], v11
    ds_read_b128 v[60:63], v12
    v_xor_b32 v11, 192, v8
    v_xor_b32 v12, 192, v10
    ds_read_b128 v[64:67], v11
    ds_read_b128 v[68:71], v12
    v_xor_b32 v11, 224, v8
    v_xor_b32 v12, 224, v10
    ds_read_b128 v[72:75], v11
    ds_read_b128 v[76:79], v12
    s_waitcnt lgkmcnt(14)
    v_mfma_f32_32x32x16_bf16 v[80:95], v[16:19], v[20:23], 0
    s_waitcnt lgkmcnt(12)
    v_mfma_f32_32x32x16_bf16 v[80:95], v[24:27], v[28:31], v[80:95]
    s_waitcnt lgkmcnt(10)
    v_mfma_f32_32x32x16_bf16 v[80:95], v[32:35], v[36:39], v[80:95]
    s_waitcnt lgkmcnt(8)
    v_mfma_f32_32x32x16_bf16 v[80:95], v[40:43], v[44:47], v[80:95]
    s_waitcnt lgkmcnt(6)
    v_mfma_f32_32x32x16_bf16 v[80:95], v[48:51], v[52:55], v[80:95]
    s_waitcnt lgkmcnt(4)
    v_mfma_f32_32x32x16_bf16 v[80:95], v[56:59], v[60:63], v[80:95]
    s_waitcnt lgkmcnt(2)
    v_mfma_f32_32x32x16_bf16 v[80:95], v[64:67], v[68:71], v[80:95]
    s_waitcnt lgkmcnt(0)
    v_mfma_f32_32x32x16_bf16 v[80:95], v[72:75], v[76:79], v[80:95]
    v_lshl_add_u32 v11, v3, 4, v5
    s_nop 15
    ds_write_b128 v11, v[80:83] offset:0
    ds_write_b128 v11, v[84:87] offset:1024
    ds_write_b128 v11, v[88:91] offset:2048
    ds_write_b128 v11, v[92:95] offset:3072
    s_waitcnt lgkmcnt(0)
    s_barrier
    v_lshlrev_b32 v11, 4, v0
    ds_read_b128 v[80:83], v11 offset:0
    ds_read_b128 v[84:87], v11 offset:13312
    ds_read_b128 v[88:91], v11 offset:26624
    ds_read_b128 v[92:95], v11 offset:39936
    s_waitcnt lgkmcnt(0)
    v_add_f32 v80, v80, v84
    v_add_f32 v88, v88, v92
    v_add_f32 v81, v81, v85
    v_add_f32 v89, v89, v93
    v_add_f32 v82, v82, v86
    v_add_f32 v90, v90, v94
    v_add_f32 v83, v83, v87
    v_add_f32 v91, v91, v95
    v_add_f32 v80, v80, v88
    v_add_f32 v81, v81, v89
    v_add_f32 v82, v82, v90
    v_add_f32 v83, v83, v91
    v_readfirstlane_b32 s27, v4
    v_and_b32 v6, 31, v3
    v_lshrrev_b32 v7, 5, v3
    v_cmp_eq_u32 vcc, 1, v7
    s_cmp_eq_u32 s27, 0
    s_cbranch_scc1 L_kg_c0
    s_cmp_eq_u32 s27, 1
    s_cbranch_scc1 L_kg_c1
    s_cmp_eq_u32 s27, 2
    s_cbranch_scc1 L_kg_c2
    s_branch L_kg_cend
L_kg_c0:
    v_lshlrev_b32 v8, 3, v6
    v_lshl_add_u32 v8, v7, 2, v8
    v_lshlrev_b32 v8, 2, v8
    ds_write_b32 v8, v80 offset:4096
    ds_write_b32 v8, v81 offset:4100
    ds_write_b32 v8, v82 offset:4104
    ds_write_b32 v8, v83 offset:4108
    s_branch L_kg_cend
L_kg_c1:
    v_lshlrev_b32 v8, 4, v6
    v_lshlrev_b32 v9, 3, v6
    v_add_u32 v8, 1024, v8
    v_add_u32 v9, 1536, v9
    v_add_u32 v10, 8, v8
    v_add_u32 v12, 256, v9
    v_cndmask_b32 v8, v8, v9, vcc
    v_cndmask_b32 v10, v10, v12, vcc
    ds_write_b32 v8, v80 offset:4096
    ds_write_b32 v8, v81 offset:4100
    ds_write_b32 v10, v82 offset:4096
    ds_write_b32 v10, v83 offset:4100
    s_branch L_kg_cend
L_kg_c2:
    v_lshlrev_b32 v8, 2, v6
    v_add_u32 v8, 2048, v8
    v_lshlrev_b32 v9, 2, v6
    v_add_u32 v9, 2560, v9
    v_cndmask_b32 v8, v8, v9, vcc
    v_mov_b32 v9, 128
    v_mov_b32 v10, 0
    v_cndmask_b32 v9, v9, v10, vcc
    ds_write_b32 v8, v80 offset:4096
    v_add_u32 v8, 128, v8
    ds_write_b32 v8, v81 offset:4096
    v_add_u32 v8, v8, v9
    ds_write_b32 v8, v82 offset:4096
    v_add_u32 v8, v8, v9
    ds_write_b32 v8, v83 offset:4096
L_kg_cend:
    s_waitcnt lgkmcnt(0)
    s_barrier
    v_add_u32 v1, 1, v0
    s_mul_i32 s24, s2, 8704
    s_add_u32 s24, s24, 4194304
    s_add_u32 s25, s24, 4352
    s_mov_b32 s26, 0
L_kg_exp:
    v_lshlrev_b32 v2, 3, v1
    v_subrev_u32 v2, 15, v2
    v_add_u32 v20, 0, v2
    v_max_i32 v21, 0, v20
    v_cvt_f32_u32 v22, v21
    v_cvt_pk_bf16_f32 v22, v22, v22
    v_lshrrev_b32 v22, 16, v22
    v_subrev_u32 v22, 17024, v22
    v_min_u32 v21, 127, v21
    v_max_i32 v22, v22, v21
    v_lshlrev_b32 v22, 2, v22
    ds_read_b32 v27, v22 offset:4096
    v_add_u32 v28, 1, v2
    v_max_i32 v29, 0, v28
    v_cvt_f32_u32 v30, v29
    v_cvt_pk_bf16_f32 v30, v30, v30
    v_lshrrev_b32 v30, 16, v30
    v_subrev_u32 v30, 17024, v30
    v_min_u32 v29, 127, v29
    v_max_i32 v30, v30, v29
    v_lshlrev_b32 v30, 2, v30
    ds_read_b32 v35, v30 offset:4096
    v_add_u32 v36, 2, v2
    v_max_i32 v37, 0, v36
    v_cvt_f32_u32 v38, v37
    v_cvt_pk_bf16_f32 v38, v38, v38
    v_lshrrev_b32 v38, 16, v38
    v_subrev_u32 v38, 17024, v38
    v_min_u32 v37, 127, v37
    v_max_i32 v38, v38, v37
    v_lshlrev_b32 v38, 2, v38
    ds_read_b32 v43, v38 offset:4096
    v_add_u32 v44, 3, v2
    v_max_i32 v45, 0, v44
    v_cvt_f32_u32 v46, v45
    v_cvt_pk_bf16_f32 v46, v46, v46
    v_lshrrev_b32 v46, 16, v46
    v_subrev_u32 v46, 17024, v46
    v_min_u32 v45, 127, v45
    v_max_i32 v46, v46, v45
    v_lshlrev_b32 v46, 2, v46
    ds_read_b32 v51, v46 offset:4096
    v_add_u32 v52, 4, v2
    v_max_i32 v53, 0, v52
    v_cvt_f32_u32 v54, v53
    v_cvt_pk_bf16_f32 v54, v54, v54
    v_lshrrev_b32 v54, 16, v54
    v_subrev_u32 v54, 17024, v54
    v_min_u32 v53, 127, v53
    v_max_i32 v54, v54, v53
    v_lshlrev_b32 v54, 2, v54
    ds_read_b32 v59, v54 offset:4096
    v_add_u32 v60, 5, v2
    v_max_i32 v61, 0, v60
    v_cvt_f32_u32 v62, v61
    v_cvt_pk_bf16_f32 v62, v62, v62
    v_lshrrev_b32 v62, 16, v62
    v_subrev_u32 v62, 17024, v62
    v_min_u32 v61, 127, v61
    v_max_i32 v62, v62, v61
    v_lshlrev_b32 v62, 2, v62
    ds_read_b32 v67, v62 offset:4096
    v_add_u32 v68, 6, v2
    v_max_i32 v69, 0, v68
    v_cvt_f32_u32 v70, v69
    v_cvt_pk_bf16_f32 v70, v70, v70
    v_lshrrev_b32 v70, 16, v70
    v_subrev_u32 v70, 17024, v70
    v_min_u32 v69, 127, v69
    v_max_i32 v70, v70, v69
    v_lshlrev_b32 v70, 2, v70
    ds_read_b32 v75, v70 offset:4096
    v_add_u32 v76, 7, v2
    v_max_i32 v77, 0, v76
    v_cvt_f32_u32 v78, v77
    v_cvt_pk_bf16_f32 v78, v78, v78
    v_lshrrev_b32 v78, 16, v78
    v_subrev_u32 v78, 17024, v78
    v_min_u32 v77, 127, v77
    v_max_i32 v78, v78, v77
    v_lshlrev_b32 v78, 2, v78
    ds_read_b32 v83, v78 offset:4096
    v_add_u32 v84, 8, v2
    v_max_i32 v85, 0, v84
    v_cvt_f32_u32 v86, v85
    v_cvt_pk_bf16_f32 v86, v86, v86
    v_lshrrev_b32 v86, 16, v86
    v_subrev_u32 v86, 17024, v86
    v_min_u32 v85, 127, v85
    v_max_i32 v86, v86, v85
    v_lshlrev_b32 v86, 2, v86
    ds_read_b32 v91, v86 offset:4096
    s_waitcnt lgkmcnt(0)
    v_cmp_le_i32 vcc, 0, v20
    s_nop 1
    v_cndmask_b32 v27, 0, v27, vcc
    v_cmp_le_i32 vcc, 0, v28
    s_nop 1
    v_cndmask_b32 v35, 0, v35, vcc
    v_cmp_le_i32 vcc, 0, v36
    s_nop 1
    v_cndmask_b32 v43, 0, v43, vcc
    v_cmp_le_i32 vcc, 0, v44
    s_nop 1
    v_cndmask_b32 v51, 0, v51, vcc
    v_cmp_le_i32 vcc, 0, v52
    s_nop 1
    v_cndmask_b32 v59, 0, v59, vcc
    v_cmp_le_i32 vcc, 0, v60
    s_nop 1
    v_cndmask_b32 v67, 0, v67, vcc
    v_cmp_le_i32 vcc, 0, v68
    s_nop 1
    v_cndmask_b32 v75, 0, v75, vcc
    v_cmp_le_i32 vcc, 0, v76
    s_nop 1
    v_cndmask_b32 v83, 0, v83, vcc
    v_cmp_le_i32 vcc, 0, v84
    s_nop 1
    v_cndmask_b32 v91, 0, v91, vcc
    v_cvt_pk_bf16_f32 v100, v27, v35
    v_cvt_pk_bf16_f32 v104, v35, v43
    v_cvt_pk_bf16_f32 v101, v43, v51
    v_cvt_pk_bf16_f32 v105, v51, v59
    v_cvt_pk_bf16_f32 v102, v59, v67
    v_cvt_pk_bf16_f32 v106, v67, v75
    v_cvt_pk_bf16_f32 v103, v75, v83
    v_cvt_pk_bf16_f32 v107, v83, v91
    v_lshlrev_b32 v3, 4, v1
    buffer_store_dwordx4 v[100:103], v3, s[20:23], s24 offen
    buffer_store_dwordx4 v[104:107], v3, s[20:23], s25 offen
    v_cmp_eq_u32 vcc, 0, v0
    s_and_saveexec_b64 s[28:29], vcc
    s_cbranch_execz L_kg_done
    v_mov_b32 v108, 0
    v_mov_b32 v109, 0
    v_mov_b32 v110, 0
    v_mov_b32 v111, 0
    v_mov_b32 v3, 0
    buffer_store_dwordx4 v[108:111], v3, s[20:23], s24 offen
    buffer_store_dwordx4 v[108:111], v3, s[20:23], s25 offen
    ds_read_b64 v[112:113], v3 offset:6648
    ds_read_b32 v114, v3 offset:6656
    s_waitcnt lgkmcnt(0)
    v_cvt_pk_bf16_f32 v20, v113, v113
    v_cvt_pk_bf16_f32 v21, v113, v114
    v_cvt_pk_bf16_f32 v22, v114, v114
    v_mov_b32 v23, v22
    v_mov_b32 v24, v20
    v_mov_b32 v25, v22
    v_mov_b32 v26, v22
    v_mov_b32 v27, v22
    v_mov_b32 v3, 4112
    buffer_store_dwordx4 v[20:23], v3, s[20:23], s24 offen
    buffer_store_dwordx4 v[24:27], v3, s[20:23], s25 offen
L_kg_done:
    s_mov_b64 exec, -1
    s_endpgm
L_k1_exit:
    s_endpgm
.globl k2_kernel
.p2align 8
.type k2_kernel,@function
k2_kernel:
    s_cmp_ge_u32 s2, 448
    s_cbranch_scc1 L_k2_exit
    s_load_dwordx2 s[4:5], s[0:1], 64
    s_load_dwordx2 s[6:7], s[0:1], 120
    v_and_b32 v1, 63, v0
    v_lshrrev_b32 v2, 6, v0
    s_nop 0
    v_readfirstlane_b32 s20, v2
    s_lshl_b32 s3, s2, 1
    v_mov_b32 v3, s3
    s_waitcnt lgkmcnt(0)
    s_mov_b32 s8, s6
    s_and_b32 s9, s7, 0xffff
    s_mov_b32 s10, 0x1900000
    s_mov_b32 s11, 0x20000
    v_and_b32 v4, 1, v1
    v_mul_u32_u24 v4, 4352, v4
    v_lshrrev_b32 v5, 1, v1
    v_lshl_add_u32 v4, v5, 2, v4
    v_lshlrev_b32 v6, 4, v1
    s_mul_i32 s21, s2, 8704
    s_add_u32 s21, s21, 4194304
    s_lshl_b32 s22, s20, 7
    s_add_u32 s21, s21, s22
    s_lshl_b32 s23, s20, 10
    s_lshl_b32 s24, s2, 12
    s_add_u32 s24, s24, s23
    s_add_u32 s25, s23, 33792
    s_mov_b32 m0, s25
    s_add_u32 s26, s24, 0
    buffer_load_dwordx4 v6, s[8:11], s26 offen lds
    s_mov_b32 m0, s23
    s_add_u32 s23, s23, 4096
    buffer_load_dwordx4 v4, s[8:11], s21 offen lds
    s_add_u32 s21, s21, 512
    s_mov_b32 m0, s23
    s_add_u32 s23, s23, 4096
    buffer_load_dwordx4 v4, s[8:11], s21 offen lds
    s_add_u32 s21, s21, 512
    s_mov_b32 m0, s23
    s_add_u32 s23, s23, 4096
    buffer_load_dwordx4 v4, s[8:11], s21 offen lds
    s_add_u32 s21, s21, 512
    s_mov_b32 m0, s23
    s_add_u32 s23, s23, 4096
    buffer_load_dwordx4 v4, s[8:11], s21 offen lds
    s_add_u32 s21, s21, 512
    s_mov_b32 m0, s23
    s_add_u32 s23, s23, 4096
    buffer_load_dwordx4 v4, s[8:11], s21 offen lds
    s_add_u32 s21, s21, 512
    s_mov_b32 m0, s23
    s_add_u32 s23, s23, 4096
    buffer_load_dwordx4 v4, s[8:11], s21 offen lds
    s_add_u32 s21, s21, 512
    s_mov_b32 m0, s23
    s_add_u32 s23, s23, 4096
    buffer_load_dwordx4 v4, s[8:11], s21 offen lds
    s_add_u32 s21, s21, 512
    s_mov_b32 m0, s23
    s_add_u32 s23, s23, 4096
    buffer_load_dwordx4 v4, s[8:11], s21 offen lds
    s_add_u32 s21, s21, 512
    s_cmp_lg_u32 s20, 0
    s_cbranch_scc1 L_cv_skip33
    s_mov_b32 m0, s23
    s_nop 0
    buffer_load_dwordx4 v4, s[8:11], s21 offen lds
L_cv_skip33:
    global_load_ushort v8, v3, s[4:5]
    v_and_b32 v9, 15, v1
    v_lshrrev_b32 v10, 4, v1
    v_lshlrev_b32 v11, 5, v9
    v_lshl_add_u32 v11, v10, 3, v11
    s_lshl_b32 s27, s2, 12
    s_lshl_b32 s28, s20, 10
    s_add_u32 s27, s27, s28
    s_add_u32 s28, s27, 2097152
    buffer_load_dwordx2 v[12:13], v11, s[8:11], s28 offen
    buffer_load_dwordx2 v[14:15], v11, s[8:11], s28 offen offset:512
    v_mov_b32 v16, 0
    v_mov_b32 v17, 0
    v_lshlrev_b32 v18, 3, v1
    ds_write_b64 v18, v[16:17] offset:37888
    v_lshl_add_u32 v20, v10, 3, v9
    v_lshlrev_b32 v20, 4, v20
    s_lshl_b32 s29, s20, 10
    v_add_u32 v20, s29, v20
    v_lshlrev_b32 v21, 4, v10
    v_lshlrev_b32 v22, 5, v9
    v_sub_u32 v21, v21, v22
    s_lshl_b32 s29, s20, 7
    s_add_u32 s29, s29, 34272
    v_add_u32 v21, s29, v21
    s_waitcnt vmcnt(3) lgkmcnt(0)
    s_barrier
    ds_read_b128 v[64:67], v21 offset:3584
    ds_read_b128 v[32:35], v20 offset:0
    ds_read_b128 v[68:71], v21 offset:3072
    ds_read_b128 v[36:39], v20 offset:4096
    ds_read_b128 v[72:75], v21 offset:2560
    ds_read_b128 v[40:43], v20 offset:8192
    ds_read_b128 v[76:79], v21 offset:2048
    ds_read_b128 v[44:47], v20 offset:12288
    ds_read_b128 v[80:83], v21 offset:1536
    ds_read_b128 v[48:51], v20 offset:16384
    ds_read_b128 v[84:87], v21 offset:1024
    ds_read_b128 v[52:55], v20 offset:20480
    ds_read_b128 v[88:91], v21 offset:512
    ds_read_b128 v[56:59], v20 offset:24576
    ds_read_b128 v[92:95], v21 offset:0
    ds_read_b128 v[60:63], v20 offset:28672
    s_waitcnt lgkmcnt(0)
    ds_read_b128 v[128:131], v21 offset:3648
    ds_read_b128 v[96:99], v20 offset:512
    ds_read_b128 v[132:135], v21 offset:3136
    ds_read_b128 v[100:103], v20 offset:4608
    ds_read_b128 v[136:139], v21 offset:2624
    ds_read_b128 v[104:107], v20 offset:8704
    ds_read_b128 v[140:143], v21 offset:2112
    ds_read_b128 v[108:111], v20 offset:12800
    ds_read_b128 v[144:147], v21 offset:1600
    ds_read_b128 v[112:115], v20 offset:16896
    ds_read_b128 v[148:151], v21 offset:1088
    ds_read_b128 v[116:119], v20 offset:20992
    ds_read_b128 v[152:155], v21 offset:576
    ds_read_b128 v[120:123], v20 offset:25088
    ds_read_b128 v[156:159], v21 offset:64
    ds_read_b128 v[124:127], v20 offset:29184
    v_mfma_f32_16x16x32_bf16 v[160:163], v[32:35], v[64:67], 0
    v_mfma_f32_16x16x32_bf16 v[164:167], v[32:35], v[68:71], 0
    v_mfma_f32_16x16x32_bf16 v[168:171], v[32:35], v[72:75], 0
    v_mfma_f32_16x16x32_bf16 v[172:175], v[32:35], v[76:79], 0
    v_mfma_f32_16x16x32_bf16 v[176:179], v[32:35], v[80:83], 0
    v_mfma_f32_16x16x32_bf16 v[180:183], v[32:35], v[84:87], 0
    v_mfma_f32_16x16x32_bf16 v[184:187], v[32:35], v[88:91], 0
    v_mfma_f32_16x16x32_bf16 v[188:191], v[32:35], v[92:95], 0
    v_mfma_f32_16x16x32_bf16 v[164:167], v[36:39], v[64:67], v[164:167]
    v_mfma_f32_16x16x32_bf16 v[168:171], v[36:39], v[68:71], v[168:171]
    v_mfma_f32_16x16x32_bf16 v[172:175], v[36:39], v[72:75], v[172:175]
    v_mfma_f32_16x16x32_bf16 v[176:179], v[36:39], v[76:79], v[176:179]
    v_mfma_f32_16x16x32_bf16 v[180:183], v[36:39], v[80:83], v[180:183]
    v_mfma_f32_16x16x32_bf16 v[184:187], v[36:39], v[84:87], v[184:187]
    v_mfma_f32_16x16x32_bf16 v[188:191], v[36:39], v[88:91], v[188:191]
    v_mfma_f32_16x16x32_bf16 v[168:171], v[40:43], v[64:67], v[168:171]
    v_mfma_f32_16x16x32_bf16 v[172:175], v[40:43], v[68:71], v[172:175]
    v_mfma_f32_16x16x32_bf16 v[176:179], v[40:43], v[72:75], v[176:179]
    v_mfma_f32_16x16x32_bf16 v[180:183], v[40:43], v[76:79], v[180:183]
    v_mfma_f32_16x16x32_bf16 v[184:187], v[40:43], v[80:83], v[184:187]
    v_mfma_f32_16x16x32_bf16 v[188:191], v[40:43], v[84:87], v[188:191]
    v_mfma_f32_16x16x32_bf16 v[172:175], v[44:47], v[64:67], v[172:175]
    v_mfma_f32_16x16x32_bf16 v[176:179], v[44:47], v[68:71], v[176:179]
    v_mfma_f32_16x16x32_bf16 v[180:183], v[44:47], v[72:75], v[180:183]
    v_mfma_f32_16x16x32_bf16 v[184:187], v[44:47], v[76:79], v[184:187]
    v_mfma_f32_16x16x32_bf16 v[188:191], v[44:47], v[80:83], v[188:191]
    v_mfma_f32_16x16x32_bf16 v[176:179], v[48:51], v[64:67], v[176:179]
    v_mfma_f32_16x16x32_bf16 v[180:183], v[48:51], v[68:71], v[180:183]
    v_mfma_f32_16x16x32_bf16 v[184:187], v[48:51], v[72:75], v[184:187]
    v_mfma_f32_16x16x32_bf16 v[188:191], v[48:51], v[76:79], v[188:191]
    v_mfma_f32_16x16x32_bf16 v[180:183], v[52:55], v[64:67], v[180:183]
    v_mfma_f32_16x16x32_bf16 v[184:187], v[52:55], v[68:71], v[184:187]
    v_mfma_f32_16x16x32_bf16 v[188:191], v[52:55], v[72:75], v[188:191]
    v_mfma_f32_16x16x32_bf16 v[184:187], v[56:59], v[64:67], v[184:187]
    v_mfma_f32_16x16x32_bf16 v[188:191], v[56:59], v[68:71], v[188:191]
    v_mfma_f32_16x16x32_bf16 v[188:191], v[60:63], v[64:67], v[188:191]
    s_waitcnt lgkmcnt(0)
    s_and_b32 s30, s2, 1
    s_mul_i32 s30, s30, 1605632
    s_lshr_b32 s31, s2, 3
    s_lshl_b32 s31, s31, 2
    s_add_u32 s31, s31, s20
    s_mul_i32 s31, s31, 7168
    s_add_u32 s30, s30, s31
    s_add_u32 s30, s30, 8388608
    s_add_u32 s30, s30, 4096
    s_mov_b32 exec_hi, -1
    v_mfma_f32_16x16x32_bf16 v[160:163], v[96:99], v[128:131], v[160:163]
    v_mfma_f32_16x16x32_bf16 v[164:167], v[96:99], v[132:135], v[164:167]
    v_mfma_f32_16x16x32_bf16 v[168:171], v[96:99], v[136:139], v[168:171]
    v_mfma_f32_16x16x32_bf16 v[172:175], v[96:99], v[140:143], v[172:175]
    v_mfma_f32_16x16x32_bf16 v[176:179], v[96:99], v[144:147], v[176:179]
    v_mfma_f32_16x16x32_bf16 v[180:183], v[96:99], v[148:151], v[180:183]
    v_mfma_f32_16x16x32_bf16 v[184:187], v[96:99], v[152:155], v[184:187]
    v_mfma_f32_16x16x32_bf16 v[188:191], v[96:99], v[156:159], v[188:191]
    v_mfma_f32_16x16x32_bf16 v[164:167], v[100:103], v[128:131], v[164:167]
    v_mfma_f32_16x16x32_bf16 v[168:171], v[100:103], v[132:135], v[168:171]
    v_mfma_f32_16x16x32_bf16 v[172:175], v[100:103], v[136:139], v[172:175]
    v_mfma_f32_16x16x32_bf16 v[176:179], v[100:103], v[140:143], v[176:179]
    v_mfma_f32_16x16x32_bf16 v[180:183], v[100:103], v[144:147], v[180:183]
    v_mfma_f32_16x16x32_bf16 v[184:187], v[100:103], v[148:151], v[184:187]
    v_mfma_f32_16x16x32_bf16 v[188:191], v[100:103], v[152:155], v[188:191]
    v_mfma_f32_16x16x32_bf16 v[168:171], v[104:107], v[128:131], v[168:171]
    v_mfma_f32_16x16x32_bf16 v[172:175], v[104:107], v[132:135], v[172:175]
    v_mfma_f32_16x16x32_bf16 v[176:179], v[104:107], v[136:139], v[176:179]
    v_mfma_f32_16x16x32_bf16 v[180:183], v[104:107], v[140:143], v[180:183]
    v_mfma_f32_16x16x32_bf16 v[184:187], v[104:107], v[144:147], v[184:187]
    v_mfma_f32_16x16x32_bf16 v[188:191], v[104:107], v[148:151], v[188:191]
    v_mfma_f32_16x16x32_bf16 v[172:175], v[108:111], v[128:131], v[172:175]
    v_mfma_f32_16x16x32_bf16 v[176:179], v[108:111], v[132:135], v[176:179]
    v_mfma_f32_16x16x32_bf16 v[180:183], v[108:111], v[136:139], v[180:183]
    v_mfma_f32_16x16x32_bf16 v[184:187], v[108:111], v[140:143], v[184:187]
    v_mfma_f32_16x16x32_bf16 v[188:191], v[108:111], v[144:147], v[188:191]
    v_mfma_f32_16x16x32_bf16 v[176:179], v[112:115], v[128:131], v[176:179]
    v_mfma_f32_16x16x32_bf16 v[180:183], v[112:115], v[132:135], v[180:183]
    v_mfma_f32_16x16x32_bf16 v[184:187], v[112:115], v[136:139], v[184:187]
    v_mfma_f32_16x16x32_bf16 v[188:191], v[112:115], v[140:143], v[188:191]
    v_mfma_f32_16x16x32_bf16 v[180:183], v[116:119], v[128:131], v[180:183]
    v_mfma_f32_16x16x32_bf16 v[184:187], v[116:119], v[132:135], v[184:187]
    v_mfma_f32_16x16x32_bf16 v[188:191], v[116:119], v[136:139], v[188:191]
    v_mfma_f32_16x16x32_bf16 v[184:187], v[120:123], v[128:131], v[184:187]
    v_mfma_f32_16x16x32_bf16 v[188:191], v[120:123], v[132:135], v[188:191]
    v_mfma_f32_16x16x32_bf16 v[188:191], v[124:127], v[128:131], v[188:191]
    s_barrier
    s_lshl_b32 s29, s20, 13
    v_add_u32 v22, s29, v6
    s_nop 7
    ds_write_b128 v22, v[160:163] offset:0
    ds_write_b128 v22, v[164:167] offset:1024
    ds_write_b128 v22, v[168:171] offset:2048
    ds_write_b128 v22, v[172:175] offset:3072
    ds_write_b128 v22, v[176:179] offset:4096
    ds_write_b128 v22, v[180:183] offset:5120
    ds_write_b128 v22, v[184:187] offset:6144
    ds_write_b128 v22, v[188:191] offset:7168
    s_waitcnt lgkmcnt(0)
    s_barrier
    s_lshl_b32 s29, s20, 11
    v_add_u32 v22, s29, v6
    ds_read_b128 v[32:35], v22 offset:0
    ds_read_b128 v[36:39], v22 offset:8192
    ds_read_b128 v[40:43], v22 offset:16384
    ds_read_b128 v[44:47], v22 offset:24576
    ds_read_b128 v[48:51], v22 offset:1024
    ds_read_b128 v[52:55], v22 offset:9216
    ds_read_b128 v[56:59], v22 offset:17408
    ds_read_b128 v[60:63], v22 offset:25600
    s_lshl_b32 s29, s20, 10
    s_sub_u32 s29, 37368, s29
    v_sub_u32 v23, s29, v11
    ds_read_b64 v[70:71], v23 offset:512
    ds_read_b64 v[72:73], v23
    s_waitcnt vmcnt(0) lgkmcnt(0)
    v_lshlrev_b32 v8, 16, v8
    v_lshrrev_b32 v24, 1, v9
    v_mul_u32_u24 v24, 28672, v24
    v_and_b32 v25, 1, v9
    v_lshl_add_u32 v24, v25, 5, v24
    v_lshl_add_u32 v24, v10, 3, v24
    s_mul_i32 s28, s20, 458752
    s_lshl_b32 s29, s2, 6
    s_add_u32 s28, s28, s29
    s_add_u32 s28, s28, 14680064
    v_add_f32 v32, v32, v36
    v_add_f32 v40, v40, v44
    v_add_f32 v33, v33, v37
    v_add_f32 v41, v41, v45
    v_add_f32 v34, v34, v38
    v_add_f32 v42, v42, v46
    v_add_f32 v35, v35, v39
    v_add_f32 v43, v43, v47
    v_add_f32 v32, v32, v40
    v_add_f32 v33, v33, v41
    v_add_f32 v34, v34, v42
    v_add_f32 v35, v35, v43
    v_cvt_pk_bf16_f32 v80, v32, v33
    v_cvt_pk_bf16_f32 v81, v34, v35
    v_lshlrev_b32 v82, 16, v80
    v_and_b32 v83, 0xffff0000, v80
    v_lshlrev_b32 v84, 16, v81
    v_and_b32 v85, 0xffff0000, v81
    v_and_b32 v86, 0xffff0000, v71
    v_lshlrev_b32 v87, 16, v71
    v_and_b32 v88, 0xffff0000, v70
    v_lshlrev_b32 v89, 16, v70
    v_mul_f32 v86, v86, v8
    v_mul_f32 v87, v87, v8
    v_mul_f32 v88, v88, v8
    v_mul_f32 v89, v89, v8
    v_cvt_pk_bf16_f32 v80, v86, v87
    v_cvt_pk_bf16_f32 v81, v88, v89
    v_lshlrev_b32 v86, 16, v80
    v_and_b32 v87, 0xffff0000, v80
    v_lshlrev_b32 v88, 16, v81
    v_and_b32 v89, 0xffff0000, v81
    v_add_f32 v82, v82, v86
    v_add_f32 v83, v83, v87
    v_add_f32 v84, v84, v88
    v_add_f32 v85, v85, v89
    v_cvt_pk_bf16_f32 v80, v82, v83
    v_cvt_pk_bf16_f32 v81, v84, v85
    v_lshlrev_b32 v82, 16, v80
    v_and_b32 v83, 0xffff0000, v80
    v_lshlrev_b32 v84, 16, v81
    v_and_b32 v85, 0xffff0000, v81
    v_lshlrev_b32 v86, 16, v12
    v_and_b32 v87, 0xffff0000, v12
    v_lshlrev_b32 v88, 16, v13
    v_and_b32 v89, 0xffff0000, v13
    v_add_f32 v82, v82, v86
    v_add_f32 v83, v83, v87
    v_add_f32 v84, v84, v88
    v_add_f32 v85, v85, v89
    v_cvt_pk_bf16_f32 v90, v82, v83
    v_cvt_pk_bf16_f32 v91, v84, v85
    buffer_store_dwordx2 v[90:91], v24, s[8:11], s28 offen
    s_add_u32 s28, s28, 229376
    v_add_f32 v48, v48, v52
    v_add_f32 v56, v56, v60
    v_add_f32 v49, v49, v53
    v_add_f32 v57, v57, v61
    v_add_f32 v50, v50, v54
    v_add_f32 v58, v58, v62
    v_add_f32 v51, v51, v55
    v_add_f32 v59, v59, v63
    v_add_f32 v48, v48, v56
    v_add_f32 v49, v49, v57
    v_add_f32 v50, v50, v58
    v_add_f32 v51, v51, v59
    v_cvt_pk_bf16_f32 v80, v48, v49
    v_cvt_pk_bf16_f32 v81, v50, v51
    v_lshlrev_b32 v82, 16, v80
    v_and_b32 v83, 0xffff0000, v80
    v_lshlrev_b32 v84, 16, v81
    v_and_b32 v85, 0xffff0000, v81
    v_and_b32 v86, 0xffff0000, v73
    v_lshlrev_b32 v87, 16, v73
    v_and_b32 v88, 0xffff0000, v72
    v_lshlrev_b32 v89, 16, v72
    v_mul_f32 v86, v86, v8
    v_mul_f32 v87, v87, v8
    v_mul_f32 v88, v88, v8
    v_mul_f32 v89, v89, v8
    v_cvt_pk_bf16_f32 v80, v86, v87
    v_cvt_pk_bf16_f32 v81, v88, v89
    v_lshlrev_b32 v86, 16, v80
    v_and_b32 v87, 0xffff0000, v80
    v_lshlrev_b32 v88, 16, v81
    v_and_b32 v89, 0xffff0000, v81
    v_add_f32 v82, v82, v86
    v_add_f32 v83, v83, v87
    v_add_f32 v84, v84, v88
    v_add_f32 v85, v85, v89
    v_cvt_pk_bf16_f32 v80, v82, v83
    v_cvt_pk_bf16_f32 v81, v84, v85
    v_lshlrev_b32 v82, 16, v80
    v_and_b32 v83, 0xffff0000, v80
    v_lshlrev_b32 v84, 16, v81
    v_and_b32 v85, 0xffff0000, v81
    v_lshlrev_b32 v86, 16, v14
    v_and_b32 v87, 0xffff0000, v14
    v_lshlrev_b32 v88, 16, v15
    v_and_b32 v89, 0xffff0000, v15
    v_add_f32 v82, v82, v86
    v_add_f32 v83, v83, v87
    v_add_f32 v84, v84, v88
    v_add_f32 v85, v85, v89
    v_cvt_pk_bf16_f32 v92, v82, v83
    v_cvt_pk_bf16_f32 v93, v84, v85
    buffer_store_dwordx2 v[92:93], v24, s[8:11], s28 offen
    s_add_u32 s28, s28, 229376
    s_endpgm
L_k2_exit:
    s_endpgm
.globl k3_kernel
.p2align 8
.type k3_kernel,@function
k3_kernel:
    s_cmp_ge_u32 s2, 256
    s_cbranch_scc1 L_k3_exit
    s_load_dwordx2 s[6:7], s[0:1], 120
    s_and_b32 s3, s2, 7
    s_lshr_b32 s4, s2, 3
    s_and_b32 s21, s3, 1
    s_lshl_b32 s21, s21, 3
    s_and_b32 s22, s4, 7
    s_add_u32 s21, s21, s22
    s_lshr_b32 s22, s3, 1
    s_lshl_b32 s22, s22, 2
    s_lshr_b32 s23, s4, 3
    s_add_u32 s22, s22, s23
    v_and_b32 v1, 63, v0
    v_lshrrev_b32 v2, 6, v0
    s_nop 0
    v_readfirstlane_b32 s20, v2
    v_lshlrev_b32 v6, 4, v1
    s_and_b32 s18, s20, 3
    s_lshr_b32 s19, s20, 2
    s_mul_i32 s29, s20, 3584
    s_mul_i32 s28, s21, 200704
    s_add_u32 s28, s28, s29
    s_add_u32 s28, s28, 8388608
    s_waitcnt lgkmcnt(0)
    s_mov_b32 s8, s6
    s_and_b32 s9, s7, 0xffff
    s_mov_b32 s10, 0x1900000
    s_mov_b32 s11, 0x20000
    s_lshl_b32 s24, s22, 2
    s_add_u32 s24, s24, s18
    s_mul_i32 s24, s24, 28672
    s_add_u32 s24, s24, 14680064
    s_lshl_b32 s25, s19, 12
    s_add_u32 s26, s24, s25
    s_lshl_b32 s27, s18, 13
    s_add_u32 s27, s27, s25
    s_mov_b32 m0, s27
    s_add_u32 s27, s27, 32768
    buffer_load_dwordx4 v6, s[8:11], s26 offen offset:0 lds
    buffer_load_dwordx4 v6, s[8:11], s26 offen offset:1024 lds
    buffer_load_dwordx4 v6, s[8:11], s26 offen offset:2048 lds
    buffer_load_dwordx4 v6, s[8:11], s26 offen offset:3072 lds
    s_add_u32 s26, s26, 8192
    s_add_u32 s30, s29, 98304
    s_add_u32 s31, s28, 0
    s_mov_b32 m0, s30
    s_nop 0
    buffer_load_dwordx4 v6, s[8:11], s31 offen lds
    buffer_load_dwordx4 v6, s[8:11], s31 offen offset:1024 lds
    buffer_load_dwordx4 v6, s[8:11], s31 offen offset:2048 lds
    s_mov_b32 exec_hi, 0
    buffer_load_dwordx4 v6, s[8:11], s31 offen offset:3072 lds
    s_mov_b32 exec_hi, -1
    s_nop 3
    s_add_u32 s30, s29, 126976
    s_add_u32 s31, s28, 28672
    s_mov_b32 m0, s30
    s_nop 0
    buffer_load_dwordx4 v6, s[8:11], s31 offen lds
    buffer_load_dwordx4 v6, s[8:11], s31 offen offset:1024 lds
    buffer_load_dwordx4 v6, s[8:11], s31 offen offset:2048 lds
    s_mov_b32 exec_hi, 0
    buffer_load_dwordx4 v6, s[8:11], s31 offen offset:3072 lds
    s_mov_b32 exec_hi, -1
    s_nop 3
    s_mul_i32 s32, s21, 896
    s_add_u32 s32, s32, 12058624
    s_mov_b32 m0, 155648
    s_mov_b32 exec_hi, 0x00ffffff
    buffer_load_dwordx4 v6, s[8:11], s32 offen lds
    s_mov_b32 exec_hi, -1
    v_and_b32 v3, 15, v1
    v_lshrrev_b32 v4, 2, v3
    v_lshlrev_b32 v4, 6, v4
    v_bfe_u32 v5, v1, 4, 1
    v_lshl_add_u32 v4, v5, 5, v4
    v_bfe_u32 v5, v1, 1, 1
    v_lshl_add_u32 v4, v5, 4, v4
    v_and_b32 v5, 1, v1
    v_lshl_add_u32 v4, v5, 3, v4
    v_lshrrev_b32 v5, 5, v1
    v_lshl_add_u32 v4, v5, 9, v4
    s_lshl_b32 s34, s18, 13
    v_add_u32 v5, s34, v4
    v_add_u32 v7, 65536, v5
    s_mov_b32 s36, 0x3f803f80
    v_mov_b32 v192, 0
    v_mov_b32 v193, 0
    v_mov_b32 v194, 0
    v_mov_b32 v195, 0
    v_mov_b32 v196, 0
    v_mov_b32 v197, 0
    v_mov_b32 v198, 0
    v_mov_b32 v199, 0
    v_mov_b32 v2, 0xc0135761
    v_mov_b32 v3, 0xbdd2d3e8
    v_lshrrev_b32 v12, 5, v1
    v_lshlrev_b32 v12, 6, v12
    s_lshl_b32 s33, s19, 7
    s_add_u32 s33, s33, 155648
    v_add_u32 v12, s33, v12
    s_lshl_b32 s41, s22, 2
    s_add_u32 s41, s41, s18
    s_mul_i32 s41, s41, 112
    s_mul_i32 s42, s21, 7
    s_add_u32 s41, s41, s42
    s_add_u32 s41, s41, s19
    s_lshl_b32 s41, s41, 10
    s_add_u32 s41, s41, 18874368
    s_cmp_eq_u32 s19, 0
    s_mov_b32 s34, 98304
    s_cselect_b32 s33, s34, 126976
    v_add_u32 v11, s33, v6
    s_mov_b32 s34, 32768
    s_cselect_b32 s33, s34, 65536
    v_add_u32 v13, s33, v6
    s_mov_b32 s34, 0
    s_cselect_b32 s33, s34, 98304
    v_add_u32 v14, s33, v6
    s_mov_b32 s34, 126976
    s_cselect_b32 s33, s34, 126976
    v_add_u32 v15, s33, v6
    s_mov_b32 m0, s27
    s_add_u32 s27, s27, 32768
    buffer_load_dwordx4 v6, s[8:11], s26 offen offset:0 lds
    buffer_load_dwordx4 v6, s[8:11], s26 offen offset:1024 lds
    buffer_load_dwordx4 v6, s[8:11], s26 offen offset:2048 lds
    buffer_load_dwordx4 v6, s[8:11], s26 offen offset:3072 lds
    s_add_u32 s26, s26, 8192
    s_waitcnt vmcnt(5)
    s_barrier
    s_mov_b32 m0, s27
    s_add_u32 s27, s27, 32768
    buffer_load_dwordx4 v6, s[8:11], s26 offen offset:0 lds
    buffer_load_dwordx4 v6, s[8:11], s26 offen offset:1024 lds
    buffer_load_dwordx4 v6, s[8:11], s26 offen offset:2048 lds
    buffer_load_dwordx4 v6, s[8:11], s26 offen offset:3072 lds
    s_add_u32 s26, s26, 8192
    ds_read_b64_tr_b16 v[16:17], v5 offset:0
    ds_read_b64_tr_b16 v[18:19], v5 offset:256
    ds_read_b64_tr_b16 v[20:21], v5 offset:1024
    ds_read_b64_tr_b16 v[22:23], v5 offset:1280
    ds_read_b64_tr_b16 v[24:25], v5 offset:2048
    ds_read_b64_tr_b16 v[26:27], v5 offset:2304
    ds_read_b64_tr_b16 v[28:29], v5 offset:3072
    ds_read_b64_tr_b16 v[30:31], v5 offset:3328
    ds_read_b64_tr_b16 v[32:33], v5 offset:4096
    ds_read_b64_tr_b16 v[34:35], v5 offset:4352
    ds_read_b64_tr_b16 v[36:37], v5 offset:5120
    ds_read_b64_tr_b16 v[38:39], v5 offset:5376
    ds_read_b64_tr_b16 v[40:41], v5 offset:6144
    ds_read_b64_tr_b16 v[42:43], v5 offset:6400
    ds_read_b64_tr_b16 v[44:45], v5 offset:7168
    ds_read_b64_tr_b16 v[46:47], v5 offset:7424
    ds_read_b128 v[160:163], v11 offset:0
    ds_read_b128 v[164:167], v11 offset:1024
    ds_read_b128 v[168:171], v11 offset:2048
    s_waitcnt lgkmcnt(3)
    s_cmp_lg_u32 s19, 0
    s_cbranch_scc1 L_k3_st1_0
    v_dot2_f32_bf16 v192, v16, s36, v192
    v_dot2_f32_bf16 v196, v16, v16, v196
    v_dot2_f32_bf16 v193, v17, s36, v193
    v_dot2_f32_bf16 v197, v17, v17, v197
    v_dot2_f32_bf16 v194, v18, s36, v194
    v_dot2_f32_bf16 v198, v18, v18, v198
    v_dot2_f32_bf16 v195, v19, s36, v195
    v_dot2_f32_bf16 v199, v19, v19, v199
    v_dot2_f32_bf16 v192, v20, s36, v192
    v_dot2_f32_bf16 v196, v20, v20, v196
    v_dot2_f32_bf16 v193, v21, s36, v193
    v_dot2_f32_bf16 v197, v21, v21, v197
    v_dot2_f32_bf16 v194, v22, s36, v194
    v_dot2_f32_bf16 v198, v22, v22, v198
    v_dot2_f32_bf16 v195, v23, s36, v195
    v_dot2_f32_bf16 v199, v23, v23, v199
    v_dot2_f32_bf16 v192, v24, s36, v192
    v_dot2_f32_bf16 v196, v24, v24, v196
    v_dot2_f32_bf16 v193, v25, s36, v193
    v_dot2_f32_bf16 v197, v25, v25, v197
    v_dot2_f32_bf16 v194, v26, s36, v194
    v_dot2_f32_bf16 v198, v26, v26, v198
    v_dot2_f32_bf16 v195, v27, s36, v195
    v_dot2_f32_bf16 v199, v27, v27, v199
    v_dot2_f32_bf16 v192, v28, s36, v192
    v_dot2_f32_bf16 v196, v28, v28, v196
    v_dot2_f32_bf16 v193, v29, s36, v193
    v_dot2_f32_bf16 v197, v29, v29, v197
    v_dot2_f32_bf16 v194, v30, s36, v194
    v_dot2_f32_bf16 v198, v30, v30, v198
    v_dot2_f32_bf16 v195, v31, s36, v195
    v_dot2_f32_bf16 v199, v31, v31, v199
    s_branch L_k3_st2_0
L_k3_st1_0:
    v_dot2_f32_bf16 v192, v32, s36, v192
    v_dot2_f32_bf16 v196, v32, v32, v196
    v_dot2_f32_bf16 v193, v33, s36, v193
    v_dot2_f32_bf16 v197, v33, v33, v197
    v_dot2_f32_bf16 v194, v34, s36, v194
    v_dot2_f32_bf16 v198, v34, v34, v198
    v_dot2_f32_bf16 v195, v35, s36, v195
    v_dot2_f32_bf16 v199, v35, v35, v199
    v_dot2_f32_bf16 v192, v36, s36, v192
    v_dot2_f32_bf16 v196, v36, v36, v196
    v_dot2_f32_bf16 v193, v37, s36, v193
    v_dot2_f32_bf16 v197, v37, v37, v197
    v_dot2_f32_bf16 v194, v38, s36, v194
    v_dot2_f32_bf16 v198, v38, v38, v198
    v_dot2_f32_bf16 v195, v39, s36, v195
    v_dot2_f32_bf16 v199, v39, v39, v199
    v_dot2_f32_bf16 v192, v40, s36, v192
    v_dot2_f32_bf16 v196, v40, v40, v196
    v_dot2_f32_bf16 v193, v41, s36, v193
    v_dot2_f32_bf16 v197, v41, v41, v197
    v_dot2_f32_bf16 v194, v42, s36, v194
    v_dot2_f32_bf16 v198, v42, v42, v198
    v_dot2_f32_bf16 v195, v43, s36, v195
    v_dot2_f32_bf16 v199, v43, v43, v199
    v_dot2_f32_bf16 v192, v44, s36, v192
    v_dot2_f32_bf16 v196, v44, v44, v196
    v_dot2_f32_bf16 v193, v45, s36, v193
    v_dot2_f32_bf16 v197, v45, v45, v197
    v_dot2_f32_bf16 v194, v46, s36, v194
    v_dot2_f32_bf16 v198, v46, v46, v198
    v_dot2_f32_bf16 v195, v47, s36, v195
    v_dot2_f32_bf16 v199, v47, v47, v199
L_k3_st2_0:
    ds_read_b128 v[172:175], v11 offset:3072
    s_waitcnt lgkmcnt(3)
    v_mfma_f32_32x32x16_bf16 v[128:143], v[160:163], v[16:19], 0
    ds_read_b128 v[160:163], v11 offset:4096
    s_waitcnt lgkmcnt(3)
    v_mfma_f32_32x32x16_bf16 v[128:143], v[164:167], v[20:23], v[128:143]
    ds_read_b128 v[164:167], v11 offset:5120
    s_waitcnt lgkmcnt(3)
    v_mfma_f32_32x32x16_bf16 v[128:143], v[168:171], v[24:27], v[128:143]
    ds_read_b128 v[168:171], v11 offset:6144
    s_waitcnt lgkmcnt(3)
    v_mfma_f32_32x32x16_bf16 v[128:143], v[172:175], v[28:31], v[128:143]
    ds_read_b128 v[172:175], v11 offset:7168
    s_waitcnt lgkmcnt(3)
    v_mfma_f32_32x32x16_bf16 v[128:143], v[160:163], v[32:35], v[128:143]
    s_waitcnt lgkmcnt(2)
    v_mfma_f32_32x32x16_bf16 v[128:143], v[164:167], v[36:39], v[128:143]
    s_waitcnt lgkmcnt(1)
    v_mfma_f32_32x32x16_bf16 v[128:143], v[168:171], v[40:43], v[128:143]
    s_waitcnt lgkmcnt(0)
    v_mfma_f32_32x32x16_bf16 v[128:143], v[172:175], v[44:47], v[128:143]
    s_waitcnt vmcnt(4)
    s_barrier
    s_lshl_b32 s25, s19, 11
    s_add_u32 s26, s24, s25
    s_add_u32 s26, s26, 24576
    s_lshl_b32 s27, s18, 13
    s_add_u32 s27, s27, s25
    s_mov_b32 m0, s27
    s_nop 0
    buffer_load_dwordx4 v6, s[8:11], s26 offen offset:0 lds
    buffer_load_dwordx4 v6, s[8:11], s26 offen offset:1024 lds
    ds_read_b64_tr_b16 v[48:49], v5 offset:32768
    ds_read_b64_tr_b16 v[50:51], v5 offset:33024
    ds_read_b64_tr_b16 v[52:53], v5 offset:33792
    ds_read_b64_tr_b16 v[54:55], v5 offset:34048
    ds_read_b64_tr_b16 v[56:57], v5 offset:34816
    ds_read_b64_tr_b16 v[58:59], v5 offset:35072
    ds_read_b64_tr_b16 v[60:61], v5 offset:35840
    ds_read_b64_tr_b16 v[62:63], v5 offset:36096
    ds_read_b64_tr_b16 v[64:65], v5 offset:36864
    ds_read_b64_tr_b16 v[66:67], v5 offset:37120
    ds_read_b64_tr_b16 v[68:69], v5 offset:37888
    ds_read_b64_tr_b16 v[70:71], v5 offset:38144
    ds_read_b64_tr_b16 v[72:73], v5 offset:38912
    ds_read_b64_tr_b16 v[74:75], v5 offset:39168
    ds_read_b64_tr_b16 v[76:77], v5 offset:39936
    ds_read_b64_tr_b16 v[78:79], v5 offset:40192
    ds_read_b128 v[160:163], v11 offset:8192
    ds_read_b128 v[164:167], v11 offset:9216
    ds_read_b128 v[168:171], v11 offset:10240
    s_waitcnt lgkmcnt(3)
    s_cmp_lg_u32 s19, 0
    s_cbranch_scc1 L_k3_st1_1
    v_dot2_f32_bf16 v192, v48, s36, v192
    v_dot2_f32_bf16 v196, v48, v48, v196
    v_dot2_f32_bf16 v193, v49, s36, v193
    v_dot2_f32_bf16 v197, v49, v49, v197
    v_dot2_f32_bf16 v194, v50, s36, v194
    v_dot2_f32_bf16 v198, v50, v50, v198
    v_dot2_f32_bf16 v195, v51, s36, v195
    v_dot2_f32_bf16 v199, v51, v51, v199
    v_dot2_f32_bf16 v192, v52, s36, v192
    v_dot2_f32_bf16 v196, v52, v52, v196
    v_dot2_f32_bf16 v193, v53, s36, v193
    v_dot2_f32_bf16 v197, v53, v53, v197
    v_dot2_f32_bf16 v194, v54, s36, v194
    v_dot2_f32_bf16 v198, v54, v54, v198
    v_dot2_f32_bf16 v195, v55, s36, v195
    v_dot2_f32_bf16 v199, v55, v55, v199
    v_dot2_f32_bf16 v192, v56, s36, v192
    v_dot2_f32_bf16 v196, v56, v56, v196
    v_dot2_f32_bf16 v193, v57, s36, v193
    v_dot2_f32_bf16 v197, v57, v57, v197
    v_dot2_f32_bf16 v194, v58, s36, v194
    v_dot2_f32_bf16 v198, v58, v58, v198
    v_dot2_f32_bf16 v195, v59, s36, v195
    v_dot2_f32_bf16 v199, v59, v59, v199
    v_dot2_f32_bf16 v192, v60, s36, v192
    v_dot2_f32_bf16 v196, v60, v60, v196
    v_dot2_f32_bf16 v193, v61, s36, v193
    v_dot2_f32_bf16 v197, v61, v61, v197
    v_dot2_f32_bf16 v194, v62, s36, v194
    v_dot2_f32_bf16 v198, v62, v62, v198
    v_dot2_f32_bf16 v195, v63, s36, v195
    v_dot2_f32_bf16 v199, v63, v63, v199
    s_branch L_k3_st2_1
L_k3_st1_1:
    v_dot2_f32_bf16 v192, v64, s36, v192
    v_dot2_f32_bf16 v196, v64, v64, v196
    v_dot2_f32_bf16 v193, v65, s36, v193
    v_dot2_f32_bf16 v197, v65, v65, v197
    v_dot2_f32_bf16 v194, v66, s36, v194
    v_dot2_f32_bf16 v198, v66, v66, v198
    v_dot2_f32_bf16 v195, v67, s36, v195
    v_dot2_f32_bf16 v199, v67, v67, v199
    v_dot2_f32_bf16 v192, v68, s36, v192
    v_dot2_f32_bf16 v196, v68, v68, v196
    v_dot2_f32_bf16 v193, v69, s36, v193
    v_dot2_f32_bf16 v197, v69, v69, v197
    v_dot2_f32_bf16 v194, v70, s36, v194
    v_dot2_f32_bf16 v198, v70, v70, v198
    v_dot2_f32_bf16 v195, v71, s36, v195
    v_dot2_f32_bf16 v199, v71, v71, v199
    v_dot2_f32_bf16 v192, v72, s36, v192
    v_dot2_f32_bf16 v196, v72, v72, v196
    v_dot2_f32_bf16 v193, v73, s36, v193
    v_dot2_f32_bf16 v197, v73, v73, v197
    v_dot2_f32_bf16 v194, v74, s36, v194
    v_dot2_f32_bf16 v198, v74, v74, v198
    v_dot2_f32_bf16 v195, v75, s36, v195
    v_dot2_f32_bf16 v199, v75, v75, v199
    v_dot2_f32_bf16 v192, v76, s36, v192
    v_dot2_f32_bf16 v196, v76, v76, v196
    v_dot2_f32_bf16 v193, v77, s36, v193
    v_dot2_f32_bf16 v197, v77, v77, v197
    v_dot2_f32_bf16 v194, v78, s36, v194
    v_dot2_f32_bf16 v198, v78, v78, v198
    v_dot2_f32_bf16 v195, v79, s36, v195
    v_dot2_f32_bf16 v199, v79, v79, v199
L_k3_st2_1:
    ds_read_b128 v[172:175], v11 offset:11264
    s_waitcnt lgkmcnt(3)
    v_mfma_f32_32x32x16_bf16 v[128:143], v[160:163], v[48:51], v[128:143]
    ds_read_b128 v[160:163], v11 offset:12288
    s_waitcnt lgkmcnt(3)
    v_mfma_f32_32x32x16_bf16 v[128:143], v[164:167], v[52:55], v[128:143]
    ds_read_b128 v[164:167], v11 offset:13312
    s_waitcnt lgkmcnt(3)
    v_mfma_f32_32x32x16_bf16 v[128:143], v[168:171], v[56:59], v[128:143]
    ds_read_b128 v[168:171], v11 offset:14336
    s_waitcnt lgkmcnt(3)
    v_mfma_f32_32x32x16_bf16 v[128:143], v[172:175], v[60:63], v[128:143]
    ds_read_b128 v[172:175], v11 offset:15360
    s_waitcnt lgkmcnt(3)
    v_mfma_f32_32x32x16_bf16 v[128:143], v[160:163], v[64:67], v[128:143]
    s_waitcnt lgkmcnt(2)
    v_mfma_f32_32x32x16_bf16 v[128:143], v[164:167], v[68:71], v[128:143]
    s_waitcnt lgkmcnt(1)
    v_mfma_f32_32x32x16_bf16 v[128:143], v[168:171], v[72:75], v[128:143]
    s_waitcnt lgkmcnt(0)
    v_mfma_f32_32x32x16_bf16 v[128:143], v[172:175], v[76:79], v[128:143]
    s_waitcnt vmcnt(2)
    s_barrier
    s_add_u32 s30, s29, 32768
    s_add_u32 s31, s28, 57344
    s_mov_b32 m0, s30
    s_nop 0
    buffer_load_dwordx4 v6, s[8:11], s31 offen lds
    buffer_load_dwordx4 v6, s[8:11], s31 offen offset:1024 lds
    buffer_load_dwordx4 v6, s[8:11], s31 offen offset:2048 lds
    s_mov_b32 exec_hi, 0
    buffer_load_dwordx4 v6, s[8:11], s31 offen offset:3072 lds
    s_mov_b32 exec_hi, -1
    s_nop 3
    ds_read_b64_tr_b16 v[80:81], v7 offset:0
    ds_read_b64_tr_b16 v[82:83], v7 offset:256
    ds_read_b64_tr_b16 v[84:85], v7 offset:1024
    ds_read_b64_tr_b16 v[86:87], v7 offset:1280
    ds_read_b64_tr_b16 v[88:89], v7 offset:2048
    ds_read_b64_tr_b16 v[90:91], v7 offset:2304
    ds_read_b64_tr_b16 v[92:93], v7 offset:3072
    ds_read_b64_tr_b16 v[94:95], v7 offset:3328
    ds_read_b64_tr_b16 v[96:97], v7 offset:4096
    ds_read_b64_tr_b16 v[98:99], v7 offset:4352
    ds_read_b64_tr_b16 v[100:101], v7 offset:5120
    ds_read_b64_tr_b16 v[102:103], v7 offset:5376
    ds_read_b64_tr_b16 v[104:105], v7 offset:6144
    ds_read_b64_tr_b16 v[106:107], v7 offset:6400
    ds_read_b64_tr_b16 v[108:109], v7 offset:7168
    ds_read_b64_tr_b16 v[110:111], v7 offset:7424
    ds_read_b128 v[160:163], v11 offset:16384
    ds_read_b128 v[164:167], v11 offset:17408
    ds_read_b128 v[168:171], v11 offset:18432
    s_waitcnt lgkmcnt(3)
    s_cmp_lg_u32 s19, 0
    s_cbranch_scc1 L_k3_st1_2
    v_dot2_f32_bf16 v192, v80, s36, v192
    v_dot2_f32_bf16 v196, v80, v80, v196
    v_dot2_f32_bf16 v193, v81, s36, v193
    v_dot2_f32_bf16 v197, v81, v81, v197
    v_dot2_f32_bf16 v194, v82, s36, v194
    v_dot2_f32_bf16 v198, v82, v82, v198
    v_dot2_f32_bf16 v195, v83, s36, v195
    v_dot2_f32_bf16 v199, v83, v83, v199
    v_dot2_f32_bf16 v192, v84, s36, v192
    v_dot2_f32_bf16 v196, v84, v84, v196
    v_dot2_f32_bf16 v193, v85, s36, v193
    v_dot2_f32_bf16 v197, v85, v85, v197
    v_dot2_f32_bf16 v194, v86, s36, v194
    v_dot2_f32_bf16 v198, v86, v86, v198
    v_dot2_f32_bf16 v195, v87, s36, v195
    v_dot2_f32_bf16 v199, v87, v87, v199
    v_dot2_f32_bf16 v192, v88, s36, v192
    v_dot2_f32_bf16 v196, v88, v88, v196
    v_dot2_f32_bf16 v193, v89, s36, v193
    v_dot2_f32_bf16 v197, v89, v89, v197
    v_dot2_f32_bf16 v194, v90, s36, v194
    v_dot2_f32_bf16 v198, v90, v90, v198
    v_dot2_f32_bf16 v195, v91, s36, v195
    v_dot2_f32_bf16 v199, v91, v91, v199
    v_dot2_f32_bf16 v192, v92, s36, v192
    v_dot2_f32_bf16 v196, v92, v92, v196
    v_dot2_f32_bf16 v193, v93, s36, v193
    v_dot2_f32_bf16 v197, v93, v93, v197
    v_dot2_f32_bf16 v194, v94, s36, v194
    v_dot2_f32_bf16 v198, v94, v94, v198
    v_dot2_f32_bf16 v195, v95, s36, v195
    v_dot2_f32_bf16 v199, v95, v95, v199
    s_branch L_k3_st2_2
L_k3_st1_2:
    v_dot2_f32_bf16 v192, v96, s36, v192
    v_dot2_f32_bf16 v196, v96, v96, v196
    v_dot2_f32_bf16 v193, v97, s36, v193
    v_dot2_f32_bf16 v197, v97, v97, v197
    v_dot2_f32_bf16 v194, v98, s36, v194
    v_dot2_f32_bf16 v198, v98, v98, v198
    v_dot2_f32_bf16 v195, v99, s36, v195
    v_dot2_f32_bf16 v199, v99, v99, v199
    v_dot2_f32_bf16 v192, v100, s36, v192
    v_dot2_f32_bf16 v196, v100, v100, v196
    v_dot2_f32_bf16 v193, v101, s36, v193
    v_dot2_f32_bf16 v197, v101, v101, v197
    v_dot2_f32_bf16 v194, v102, s36, v194
    v_dot2_f32_bf16 v198, v102, v102, v198
    v_dot2_f32_bf16 v195, v103, s36, v195
    v_dot2_f32_bf16 v199, v103, v103, v199
    v_dot2_f32_bf16 v192, v104, s36, v192
    v_dot2_f32_bf16 v196, v104, v104, v196
    v_dot2_f32_bf16 v193, v105, s36, v193
    v_dot2_f32_bf16 v197, v105, v105, v197
    v_dot2_f32_bf16 v194, v106, s36, v194
    v_dot2_f32_bf16 v198, v106, v106, v198
    v_dot2_f32_bf16 v195, v107, s36, v195
    v_dot2_f32_bf16 v199, v107, v107, v199
    v_dot2_f32_bf16 v192, v108, s36, v192
    v_dot2_f32_bf16 v196, v108, v108, v196
    v_dot2_f32_bf16 v193, v109, s36, v193
    v_dot2_f32_bf16 v197, v109, v109, v197
    v_dot2_f32_bf16 v194, v110, s36, v194
    v_dot2_f32_bf16 v198, v110, v110, v198
    v_dot2_f32_bf16 v195, v111, s36, v195
    v_dot2_f32_bf16 v199, v111, v111, v199
L_k3_st2_2:
    ds_read_b128 v[172:175], v11 offset:19456
    s_waitcnt lgkmcnt(3)
    v_mfma_f32_32x32x16_bf16 v[128:143], v[160:163], v[80:83], v[128:143]
    ds_read_b128 v[160:163], v11 offset:20480
    s_waitcnt lgkmcnt(3)
    v_mfma_f32_32x32x16_bf16 v[128:143], v[164:167], v[84:87], v[128:143]
    ds_read_b128 v[164:167], v11 offset:21504
    s_waitcnt lgkmcnt(3)
    v_mfma_f32_32x32x16_bf16 v[128:143], v[168:171], v[88:91], v[128:143]
    ds_read_b128 v[168:171], v11 offset:22528
    s_waitcnt lgkmcnt(3)
    v_mfma_f32_32x32x16_bf16 v[128:143], v[172:175], v[92:95], v[128:143]
    ds_read_b128 v[172:175], v11 offset:23552
    s_waitcnt lgkmcnt(3)
    v_mfma_f32_32x32x16_bf16 v[128:143], v[160:163], v[96:99], v[128:143]
    s_waitcnt lgkmcnt(2)
    v_mfma_f32_32x32x16_bf16 v[128:143], v[164:167], v[100:103], v[128:143]
    s_waitcnt lgkmcnt(1)
    v_mfma_f32_32x32x16_bf16 v[128:143], v[168:171], v[104:107], v[128:143]
    s_waitcnt lgkmcnt(0)
    v_mfma_f32_32x32x16_bf16 v[128:143], v[172:175], v[108:111], v[128:143]
    s_waitcnt vmcnt(4)
    s_barrier
    s_add_u32 s30, s29, 65536
    s_add_u32 s31, s28, 86016
    s_mov_b32 m0, s30
    s_nop 0
    buffer_load_dwordx4 v6, s[8:11], s31 offen lds
    buffer_load_dwordx4 v6, s[8:11], s31 offen offset:1024 lds
    buffer_load_dwordx4 v6, s[8:11], s31 offen offset:2048 lds
    s_mov_b32 exec_hi, 0
    buffer_load_dwordx4 v6, s[8:11], s31 offen offset:3072 lds
    s_mov_b32 exec_hi, -1
    s_nop 3
    ds_read_b64_tr_b16 v[112:113], v5 offset:0
    ds_read_b64_tr_b16 v[114:115], v5 offset:256
    ds_read_b64_tr_b16 v[116:117], v5 offset:1024
    ds_read_b64_tr_b16 v[118:119], v5 offset:1280
    ds_read_b64_tr_b16 v[120:121], v5 offset:2048
    ds_read_b64_tr_b16 v[122:123], v5 offset:2304
    ds_read_b64_tr_b16 v[124:125], v5 offset:3072
    ds_read_b64_tr_b16 v[126:127], v5 offset:3328
    ds_read_b128 v[160:163], v11 offset:24576
    ds_read_b128 v[164:167], v11 offset:25600
    ds_read_b128 v[168:171], v11 offset:26624
    s_waitcnt lgkmcnt(3)
    s_cmp_lg_u32 s19, 0
    s_cbranch_scc1 L_k3_st1_3
    v_dot2_f32_bf16 v192, v112, s36, v192
    v_dot2_f32_bf16 v196, v112, v112, v196
    v_dot2_f32_bf16 v193, v113, s36, v193
    v_dot2_f32_bf16 v197, v113, v113, v197
    v_dot2_f32_bf16 v194, v114, s36, v194
    v_dot2_f32_bf16 v198, v114, v114, v198
    v_dot2_f32_bf16 v195, v115, s36, v195
    v_dot2_f32_bf16 v199, v115, v115, v199
    v_dot2_f32_bf16 v192, v116, s36, v192
    v_dot2_f32_bf16 v196, v116, v116, v196
    v_dot2_f32_bf16 v193, v117, s36, v193
    v_dot2_f32_bf16 v197, v117, v117, v197
    v_dot2_f32_bf16 v194, v118, s36, v194
    v_dot2_f32_bf16 v198, v118, v118, v198
    v_dot2_f32_bf16 v195, v119, s36, v195
    v_dot2_f32_bf16 v199, v119, v119, v199
    s_branch L_k3_st2_3
L_k3_st1_3:
    v_dot2_f32_bf16 v192, v120, s36, v192
    v_dot2_f32_bf16 v196, v120, v120, v196
    v_dot2_f32_bf16 v193, v121, s36, v193
    v_dot2_f32_bf16 v197, v121, v121, v197
    v_dot2_f32_bf16 v194, v122, s36, v194
    v_dot2_f32_bf16 v198, v122, v122, v198
    v_dot2_f32_bf16 v195, v123, s36, v195
    v_dot2_f32_bf16 v199, v123, v123, v199
    v_dot2_f32_bf16 v192, v124, s36, v192
    v_dot2_f32_bf16 v196, v124, v124, v196
    v_dot2_f32_bf16 v193, v125, s36, v193
    v_dot2_f32_bf16 v197, v125, v125, v197
    v_dot2_f32_bf16 v194, v126, s36, v194
    v_dot2_f32_bf16 v198, v126, v126, v198
    v_dot2_f32_bf16 v195, v127, s36, v195
    v_dot2_f32_bf16 v199, v127, v127, v199
L_k3_st2_3:
    ds_read_b128 v[172:175], v11 offset:27648
    s_waitcnt lgkmcnt(3)
    v_mfma_f32_32x32x16_bf16 v[128:143], v[160:163], v[112:115], v[128:143]
    s_waitcnt lgkmcnt(2)
    v_mfma_f32_32x32x16_bf16 v[128:143], v[164:167], v[116:119], v[128:143]
    s_waitcnt lgkmcnt(1)
    v_mfma_f32_32x32x16_bf16 v[128:143], v[168:171], v[120:123], v[128:143]
    s_waitcnt lgkmcnt(0)
    v_mfma_f32_32x32x16_bf16 v[128:143], v[172:175], v[124:127], v[128:143]
    s_nop 3
    v_add_f32 v192, v192, v193
    v_add_f32 v194, v194, v195
    v_add_f32 v196, v196, v197
    v_add_f32 v198, v198, v199
    v_add_f32 v192, v192, v194
    v_add_f32 v193, v196, v198
    s_lshl_b32 s33, s20, 9
    s_add_u32 s33, s33, 159744
    v_lshl_add_u32 v200, v1, 3, s33
    ds_write_b64 v200, v[192:193]
    s_xor_b32 s33, s33, 2048
    v_lshl_add_u32 v200, v1, 3, s33
    s_waitcnt lgkmcnt(0)
    s_waitcnt vmcnt(0)
    s_barrier
    ds_read_b64 v[194:195], v200
    ds_read_b128 v[160:163], v13 offset:0
    ds_read_b128 v[164:167], v13 offset:1024
    ds_read_b128 v[168:171], v13 offset:2048
    s_waitcnt lgkmcnt(3)
    v_add_f32 v192, v192, v194
    v_add_f32 v196, v193, v195
    v_mov_b32 v193, v192
    v_mov_b32 v197, v196
    s_nop 1
    v_permlane32_swap_b32 v192, v193
    v_permlane32_swap_b32 v196, v197
    s_nop 1
    v_add_f32 v192, v192, v193
    v_add_f32 v196, v196, v197
    v_mul_f32 v192, 0x3b124925, v192
    v_mul_f32 v196, 0x3b124925, v196
    v_fma_f32 v196, -v192, v192, v196
    v_max_f32 v196, 0, v196
    v_cvt_pk_bf16_f32 v200, v192, v196
    v_lshlrev_b32 v8, 16, v200
    v_and_b32 v9, 0xffff0000, v200
    v_add_f32 v9, 0x3727c5ac, v9
    v_cvt_pk_bf16_f32 v200, v9, v9
    v_and_b32 v9, 0xffff0000, v200
    v_sqrt_f32 v9, v9
    s_nop 0
    v_cvt_pk_bf16_f32 v200, v9, v9
    v_and_b32 v9, 0xffff0000, v200
    v_rcp_f32 v201, v9
    v_sub_f32 v8, 0, v8
    v_fma_f32 v202, -v9, v201, 1.0
    v_fma_f32 v9, v202, v201, v201
    ds_read_b128 v[172:175], v13 offset:3072
    s_waitcnt lgkmcnt(3)
    v_mfma_f32_32x32x16_bf16 v[144:159], v[160:163], v[16:19], 0
    s_add_u32 s30, s29, 0
    s_add_u32 s31, s28, 114688
    s_mov_b32 m0, s30
    s_nop 0
    buffer_load_dwordx4 v6, s[8:11], s31 offen lds
    ds_read_b128 v[176:179], v12 offset:0
    ds_read_b128 v[180:183], v12 offset:16
    ds_read_b128 v[184:187], v12 offset:32
    ds_read_b128 v[188:191], v12 offset:48
    ds_read_b128 v[160:163], v13 offset:4096
    s_waitcnt lgkmcnt(7)
    v_mfma_f32_32x32x16_bf16 v[144:159], v[164:167], v[20:23], v[144:159]
    ds_read_b128 v[164:167], v13 offset:5120
    s_waitcnt lgkmcnt(7)
    v_mfma_f32_32x32x16_bf16 v[144:159], v[168:171], v[24:27], v[144:159]
    buffer_load_dwordx4 v6, s[8:11], s31 offen offset:1024 lds
    s_waitcnt lgkmcnt(2)
    v_fma_f32 v128, v8, v176, v128
    v_fma_f32 v129, v8, v177, v129
    v_fma_f32 v130, v8, v178, v130
    v_fma_f32 v131, v8, v179, v131
    ds_read_b128 v[168:171], v13 offset:6144
    s_waitcnt lgkmcnt(7)
    v_mfma_f32_32x32x16_bf16 v[144:159], v[172:175], v[28:31], v[144:159]
    v_fma_f32 v132, v8, v180, v132
    v_fma_f32 v133, v8, v181, v133
    v_fma_f32 v134, v8, v182, v134
    v_fma_f32 v135, v8, v183, v135
    ds_read_b128 v[172:175], v13 offset:7168
    s_waitcnt lgkmcnt(3)
    v_mfma_f32_32x32x16_bf16 v[144:159], v[160:163], v[32:35], v[144:159]
    buffer_load_dwordx4 v6, s[8:11], s31 offen offset:2048 lds
    v_fma_f32 v136, v8, v184, v136
    v_fma_f32 v137, v8, v185, v137
    v_fma_f32 v138, v8, v186, v138
    v_fma_f32 v139, v8, v187, v139
    ds_read_b128 v[160:163], v13 offset:8192
    s_waitcnt lgkmcnt(3)
    v_mfma_f32_32x32x16_bf16 v[144:159], v[164:167], v[36:39], v[144:159]
    v_fma_f32 v140, v8, v188, v140
    v_fma_f32 v141, v8, v189, v141
    v_fma_f32 v142, v8, v190, v142
    v_fma_f32 v143, v8, v191, v143
    ds_read_b128 v[164:167], v13 offset:9216
    s_waitcnt lgkmcnt(3)
    v_mfma_f32_32x32x16_bf16 v[144:159], v[168:171], v[40:43], v[144:159]
    s_mov_b32 exec_hi, 0
    buffer_load_dwordx4 v6, s[8:11], s31 offen offset:3072 lds
    s_mov_b32 exec_hi, -1
    s_nop 3
    v_mul_f32 v128, v9, v128
    v_mul_f32 v129, v9, v129
    v_mul_f32 v130, v9, v130
    v_mul_f32 v131, v9, v131
    ds_read_b128 v[168:171], v13 offset:10240
    s_waitcnt lgkmcnt(3)
    v_mfma_f32_32x32x16_bf16 v[144:159], v[172:175], v[44:47], v[144:159]
    v_mul_f32 v132, v9, v132
    v_mul_f32 v133, v9, v133
    v_mul_f32 v134, v9, v134
    v_mul_f32 v135, v9, v135
    ds_read_b128 v[172:175], v13 offset:11264
    s_waitcnt lgkmcnt(3)
    v_mfma_f32_32x32x16_bf16 v[144:159], v[160:163], v[48:51], v[144:159]
    s_add_u32 s30, s29, 98304
    s_add_u32 s31, s28, 143360
    s_mov_b32 m0, s30
    s_nop 0
    buffer_load_dwordx4 v6, s[8:11], s31 offen lds
    v_mul_f32 v136, v9, v136
    v_mul_f32 v137, v9, v137
    v_mul_f32 v138, v9, v138
    v_mul_f32 v139, v9, v139
    ds_read_b128 v[160:163], v13 offset:12288
    s_waitcnt lgkmcnt(3)
    v_mfma_f32_32x32x16_bf16 v[144:159], v[164:167], v[52:55], v[144:159]
    v_mul_f32 v140, v9, v140
    v_mul_f32 v141, v9, v141
    v_mul_f32 v142, v9, v142
    v_mul_f32 v143, v9, v143
    ds_read_b128 v[164:167], v13 offset:13312
    s_waitcnt lgkmcnt(3)
    v_mfma_f32_32x32x16_bf16 v[144:159], v[168:171], v[56:59], v[144:159]
    buffer_load_dwordx4 v6, s[8:11], s31 offen offset:1024 lds
    v_mul_f32 v208, v128, v128
    v_mul_f32 v209, v129, v129
    v_mul_f32 v210, v130, v130
    v_mul_f32 v211, v131, v131
    ds_read_b128 v[168:171], v13 offset:14336
    s_waitcnt lgkmcnt(3)
    v_mfma_f32_32x32x16_bf16 v[144:159], v[172:175], v[60:63], v[144:159]
    v_mul_f32 v212, v132, v132
    v_mul_f32 v213, v133, v133
    v_mul_f32 v214, v134, v134
    v_mul_f32 v215, v135, v135
    ds_read_b128 v[172:175], v13 offset:15360
    s_waitcnt lgkmcnt(3)
    v_mfma_f32_32x32x16_bf16 v[144:159], v[160:163], v[64:67], v[144:159]
    buffer_load_dwordx4 v6, s[8:11], s31 offen offset:2048 lds
    v_fma_f32 v208, v208, v3, v2
    v_fma_f32 v209, v209, v3, v2
    v_fma_f32 v210, v210, v3, v2
    v_fma_f32 v211, v211, v3, v2
    ds_read_b128 v[160:163], v13 offset:16384
    s_waitcnt lgkmcnt(3)
    v_mfma_f32_32x32x16_bf16 v[144:159], v[164:167], v[68:71], v[144:159]
    v_fma_f32 v212, v212, v3, v2
    v_fma_f32 v213, v213, v3, v2
    v_fma_f32 v214, v214, v3, v2
    v_fma_f32 v215, v215, v3, v2
    ds_read_b128 v[164:167], v13 offset:17408
    s_waitcnt lgkmcnt(3)
    v_mfma_f32_32x32x16_bf16 v[144:159], v[168:171], v[72:75], v[144:159]
    s_mov_b32 exec_hi, 0
    buffer_load_dwordx4 v6, s[8:11], s31 offen offset:3072 lds
    s_mov_b32 exec_hi, -1
    s_nop 3
    v_mul_f32 v208, v208, v128
    v_mul_f32 v209, v209, v129
    v_mul_f32 v210, v210, v130
    v_mul_f32 v211, v211, v131
    ds_read_b128 v[168:171], v13 offset:18432
    s_waitcnt lgkmcnt(3)
    v_mfma_f32_32x32x16_bf16 v[144:159], v[172:175], v[76:79], v[144:159]
    v_mul_f32 v212, v212, v132
    v_mul_f32 v213, v213, v133
    v_mul_f32 v214, v214, v134
    v_mul_f32 v215, v215, v135
    ds_read_b128 v[172:175], v13 offset:19456
    s_waitcnt lgkmcnt(3)
    v_mfma_f32_32x32x16_bf16 v[144:159], v[160:163], v[80:83], v[144:159]
    s_add_u32 s30, s29, 126976
    s_add_u32 s31, s28, 172032
    s_mov_b32 m0, s30
    s_nop 0
    buffer_load_dwordx4 v6, s[8:11], s31 offen lds
    v_exp_f32 v208, v208
    v_exp_f32 v209, v209
    v_exp_f32 v210, v210
    v_exp_f32 v211, v211
    ds_read_b128 v[160:163], v13 offset:20480
    s_waitcnt lgkmcnt(3)
    v_mfma_f32_32x32x16_bf16 v[144:159], v[164:167], v[84:87], v[144:159]
    v_exp_f32 v212, v212
    v_exp_f32 v213, v213
    v_exp_f32 v214, v214
    v_exp_f32 v215, v215
    ds_read_b128 v[164:167], v13 offset:21504
    s_waitcnt lgkmcnt(3)
    v_mfma_f32_32x32x16_bf16 v[144:159], v[168:171], v[88:91], v[144:159]
    buffer_load_dwordx4 v6, s[8:11], s31 offen offset:1024 lds
    v_mul_f32 v128, v128, v136
    v_mul_f32 v129, v129, v137
    v_mul_f32 v130, v130, v138
    v_mul_f32 v131, v131, v139
    ds_read_b128 v[168:171], v13 offset:22528
    s_waitcnt lgkmcnt(3)
    v_mfma_f32_32x32x16_bf16 v[144:159], v[172:175], v[92:95], v[144:159]
    v_mul_f32 v132, v132, v140
    v_mul_f32 v133, v133, v141
    v_mul_f32 v134, v134, v142
    v_mul_f32 v135, v135, v143
    ds_read_b128 v[172:175], v13 offset:23552
    s_waitcnt lgkmcnt(3)
    v_mfma_f32_32x32x16_bf16 v[144:159], v[160:163], v[96:99], v[144:159]
    buffer_load_dwordx4 v6, s[8:11], s31 offen offset:2048 lds
    v_add_f32 v208, 1.0, v208
    v_add_f32 v209, 1.0, v209
    v_add_f32 v210, 1.0, v210
    v_add_f32 v211, 1.0, v211
    ds_read_b128 v[160:163], v13 offset:24576
    s_waitcnt lgkmcnt(3)
    v_mfma_f32_32x32x16_bf16 v[144:159], v[164:167], v[100:103], v[144:159]
    v_add_f32 v212, 1.0, v212
    v_add_f32 v213, 1.0, v213
    v_add_f32 v214, 1.0, v214
    v_add_f32 v215, 1.0, v215
    ds_read_b128 v[164:167], v13 offset:25600
    s_waitcnt lgkmcnt(3)
    v_mfma_f32_32x32x16_bf16 v[144:159], v[168:171], v[104:107], v[144:159]
    s_mov_b32 exec_hi, 0
    buffer_load_dwordx4 v6, s[8:11], s31 offen offset:3072 lds
    s_mov_b32 exec_hi, -1
    s_nop 3
    v_rcp_f32 v208, v208
    v_rcp_f32 v209, v209
    v_rcp_f32 v210, v210
    v_rcp_f32 v211, v211
    ds_read_b128 v[168:171], v13 offset:26624
    s_waitcnt lgkmcnt(3)
    v_mfma_f32_32x32x16_bf16 v[144:159], v[172:175], v[108:111], v[144:159]
    v_rcp_f32 v212, v212
    v_rcp_f32 v213, v213
    v_rcp_f32 v214, v214
    v_rcp_f32 v215, v215
    ds_read_b128 v[172:175], v13 offset:27648
    s_waitcnt lgkmcnt(3)
    v_mfma_f32_32x32x16_bf16 v[144:159], v[160:163], v[112:115], v[144:159]
    v_mul_f32 v128, v128, v208
    v_mul_f32 v129, v129, v209
    v_mul_f32 v130, v130, v210
    v_mul_f32 v131, v131, v211
    s_waitcnt vmcnt(4)
    s_barrier
    ds_read_b128 v[160:163], v14 offset:0
    s_waitcnt lgkmcnt(3)
    v_mfma_f32_32x32x16_bf16 v[144:159], v[164:167], v[116:119], v[144:159]
    v_mul_f32 v132, v132, v212
    v_mul_f32 v133, v133, v213
    v_mul_f32 v134, v134, v214
    v_mul_f32 v135, v135, v215
    ds_read_b128 v[164:167], v14 offset:1024
    s_waitcnt lgkmcnt(3)
    v_mfma_f32_32x32x16_bf16 v[144:159], v[168:171], v[120:123], v[144:159]
    v_cvt_pk_bf16_f32 v224, v128, v129
    v_cvt_pk_bf16_f32 v225, v130, v131
    v_cvt_pk_bf16_f32 v226, v132, v133
    v_cvt_pk_bf16_f32 v227, v134, v135
    ds_read_b128 v[168:171], v14 offset:2048
    s_waitcnt lgkmcnt(3)
    v_mfma_f32_32x32x16_bf16 v[144:159], v[172:175], v[124:127], v[144:159]
    buffer_store_dwordx4 v[224:227], v6, s[8:11], s41 offen offset:0 sc1
    ds_read_b128 v[172:175], v14 offset:3072
    s_waitcnt lgkmcnt(3)
    v_mfma_f32_32x32x16_bf16 v[128:143], v[160:163], v[16:19], 0
    ds_read_b128 v[176:179], v12 offset:256
    ds_read_b128 v[180:183], v12 offset:272
    ds_read_b128 v[184:187], v12 offset:288
    ds_read_b128 v[188:191], v12 offset:304
    ds_read_b128 v[160:163], v14 offset:4096
    s_waitcnt lgkmcnt(7)
    v_mfma_f32_32x32x16_bf16 v[128:143], v[164:167], v[20:23], v[128:143]
    ds_read_b128 v[164:167], v14 offset:5120
    s_waitcnt lgkmcnt(7)
    v_mfma_f32_32x32x16_bf16 v[128:143], v[168:171], v[24:27], v[128:143]
    s_waitcnt lgkmcnt(2)
    v_fma_f32 v144, v8, v176, v144
    v_fma_f32 v145, v8, v177, v145
    v_fma_f32 v146, v8, v178, v146
    v_fma_f32 v147, v8, v179, v147
    ds_read_b128 v[168:171], v14 offset:6144
    s_waitcnt lgkmcnt(7)
    v_mfma_f32_32x32x16_bf16 v[128:143], v[172:175], v[28:31], v[128:143]
    v_fma_f32 v148, v8, v180, v148
    v_fma_f32 v149, v8, v181, v149
    v_fma_f32 v150, v8, v182, v150
    v_fma_f32 v151, v8, v183, v151
    ds_read_b128 v[172:175], v14 offset:7168
    s_waitcnt lgkmcnt(3)
    v_mfma_f32_32x32x16_bf16 v[128:143], v[160:163], v[32:35], v[128:143]
    v_fma_f32 v152, v8, v184, v152
    v_fma_f32 v153, v8, v185, v153
    v_fma_f32 v154, v8, v186, v154
    v_fma_f32 v155, v8, v187, v155
    ds_read_b128 v[160:163], v14 offset:8192
    s_waitcnt lgkmcnt(3)
    v_mfma_f32_32x32x16_bf16 v[128:143], v[164:167], v[36:39], v[128:143]
    v_fma_f32 v156, v8, v188, v156
    v_fma_f32 v157, v8, v189, v157
    v_fma_f32 v158, v8, v190, v158
    v_fma_f32 v159, v8, v191, v159
    ds_read_b128 v[164:167], v14 offset:9216
    s_waitcnt lgkmcnt(3)
    v_mfma_f32_32x32x16_bf16 v[128:143], v[168:171], v[40:43], v[128:143]
    v_mul_f32 v144, v9, v144
    v_mul_f32 v145, v9, v145
    v_mul_f32 v146, v9, v146
    v_mul_f32 v147, v9, v147
    ds_read_b128 v[168:171], v14 offset:10240
    s_waitcnt lgkmcnt(3)
    v_mfma_f32_32x32x16_bf16 v[128:143], v[172:175], v[44:47], v[128:143]
    v_mul_f32 v148, v9, v148
    v_mul_f32 v149, v9, v149
    v_mul_f32 v150, v9, v150
    v_mul_f32 v151, v9, v151
    ds_read_b128 v[172:175], v14 offset:11264
    s_waitcnt lgkmcnt(3)
    v_mfma_f32_32x32x16_bf16 v[128:143], v[160:163], v[48:51], v[128:143]
    v_mul_f32 v152, v9, v152
    v_mul_f32 v153, v9, v153
    v_mul_f32 v154, v9, v154
    v_mul_f32 v155, v9, v155
    ds_read_b128 v[160:163], v14 offset:12288
    s_waitcnt lgkmcnt(3)
    v_mfma_f32_32x32x16_bf16 v[128:143], v[164:167], v[52:55], v[128:143]
    v_mul_f32 v156, v9, v156
    v_mul_f32 v157, v9, v157
    v_mul_f32 v158, v9, v158
    v_mul_f32 v159, v9, v159
    ds_read_b128 v[164:167], v14 offset:13312
    s_waitcnt lgkmcnt(3)
    v_mfma_f32_32x32x16_bf16 v[128:143], v[168:171], v[56:59], v[128:143]
    v_mul_f32 v208, v144, v144
    v_mul_f32 v209, v145, v145
    v_mul_f32 v210, v146, v146
    v_mul_f32 v211, v147, v147
    ds_read_b128 v[168:171], v14 offset:14336
    s_waitcnt lgkmcnt(3)
    v_mfma_f32_32x32x16_bf16 v[128:143], v[172:175], v[60:63], v[128:143]
    v_mul_f32 v212, v148, v148
    v_mul_f32 v213, v149, v149
    v_mul_f32 v214, v150, v150
    v_mul_f32 v215, v151, v151
    ds_read_b128 v[172:175], v14 offset:15360
    s_waitcnt lgkmcnt(3)
    v_mfma_f32_32x32x16_bf16 v[128:143], v[160:163], v[64:67], v[128:143]
    v_fma_f32 v208, v208, v3, v2
    v_fma_f32 v209, v209, v3, v2
    v_fma_f32 v210, v210, v3, v2
    v_fma_f32 v211, v211, v3, v2
    ds_read_b128 v[160:163], v14 offset:16384
    s_waitcnt lgkmcnt(3)
    v_mfma_f32_32x32x16_bf16 v[128:143], v[164:167], v[68:71], v[128:143]
    v_fma_f32 v212, v212, v3, v2
    v_fma_f32 v213, v213, v3, v2
    v_fma_f32 v214, v214, v3, v2
    v_fma_f32 v215, v215, v3, v2
    ds_read_b128 v[164:167], v14 offset:17408
    s_waitcnt lgkmcnt(3)
    v_mfma_f32_32x32x16_bf16 v[128:143], v[168:171], v[72:75], v[128:143]
    v_mul_f32 v208, v208, v144
    v_mul_f32 v209, v209, v145
    v_mul_f32 v210, v210, v146
    v_mul_f32 v211, v211, v147
    ds_read_b128 v[168:171], v14 offset:18432
    s_waitcnt lgkmcnt(3)
    v_mfma_f32_32x32x16_bf16 v[128:143], v[172:175], v[76:79], v[128:143]
    v_mul_f32 v212, v212, v148
    v_mul_f32 v213, v213, v149
    v_mul_f32 v214, v214, v150
    v_mul_f32 v215, v215, v151
    ds_read_b128 v[172:175], v14 offset:19456
    s_waitcnt lgkmcnt(3)
    v_mfma_f32_32x32x16_bf16 v[128:143], v[160:163], v[80:83], v[128:143]
    v_exp_f32 v208, v208
    v_exp_f32 v209, v209
    v_exp_f32 v210, v210
    v_exp_f32 v211, v211
    ds_read_b128 v[160:163], v14 offset:20480
    s_waitcnt lgkmcnt(3)
    v_mfma_f32_32x32x16_bf16 v[128:143], v[164:167], v[84:87], v[128:143]
    v_exp_f32 v212, v212
    v_exp_f32 v213, v213
    v_exp_f32 v214, v214
    v_exp_f32 v215, v215
    ds_read_b128 v[164:167], v14 offset:21504
    s_waitcnt lgkmcnt(3)
    v_mfma_f32_32x32x16_bf16 v[128:143], v[168:171], v[88:91], v[128:143]
    v_mul_f32 v144, v144, v152
    v_mul_f32 v145, v145, v153
    v_mul_f32 v146, v146, v154
    v_mul_f32 v147, v147, v155
    ds_read_b128 v[168:171], v14 offset:22528
    s_waitcnt lgkmcnt(3)
    v_mfma_f32_32x32x16_bf16 v[128:143], v[172:175], v[92:95], v[128:143]
    v_mul_f32 v148, v148, v156
    v_mul_f32 v149, v149, v157
    v_mul_f32 v150, v150, v158
    v_mul_f32 v151, v151, v159
    ds_read_b128 v[172:175], v14 offset:23552
    s_waitcnt lgkmcnt(3)
    v_mfma_f32_32x32x16_bf16 v[128:143], v[160:163], v[96:99], v[128:143]
    v_add_f32 v208, 1.0, v208
    v_add_f32 v209, 1.0, v209
    v_add_f32 v210, 1.0, v210
    v_add_f32 v211, 1.0, v211
    ds_read_b128 v[160:163], v14 offset:24576
    s_waitcnt lgkmcnt(3)
    v_mfma_f32_32x32x16_bf16 v[128:143], v[164:167], v[100:103], v[128:143]
    v_add_f32 v212, 1.0, v212
    v_add_f32 v213, 1.0, v213
    v_add_f32 v214, 1.0, v214
    v_add_f32 v215, 1.0, v215
    ds_read_b128 v[164:167], v14 offset:25600
    s_waitcnt lgkmcnt(3)
    v_mfma_f32_32x32x16_bf16 v[128:143], v[168:171], v[104:107], v[128:143]
    v_rcp_f32 v208, v208
    v_rcp_f32 v209, v209
    v_rcp_f32 v210, v210
    v_rcp_f32 v211, v211
    ds_read_b128 v[168:171], v14 offset:26624
    s_waitcnt lgkmcnt(3)
    v_mfma_f32_32x32x16_bf16 v[128:143], v[172:175], v[108:111], v[128:143]
    v_rcp_f32 v212, v212
    v_rcp_f32 v213, v213
    v_rcp_f32 v214, v214
    v_rcp_f32 v215, v215
    ds_read_b128 v[172:175], v14 offset:27648
    s_waitcnt lgkmcnt(3)
    v_mfma_f32_32x32x16_bf16 v[128:143], v[160:163], v[112:115], v[128:143]
    v_mul_f32 v144, v144, v208
    v_mul_f32 v145, v145, v209
    v_mul_f32 v146, v146, v210
    v_mul_f32 v147, v147, v211
    s_waitcnt vmcnt(1)
    s_barrier
    ds_read_b128 v[160:163], v15 offset:0
    s_waitcnt lgkmcnt(3)
    v_mfma_f32_32x32x16_bf16 v[128:143], v[164:167], v[116:119], v[128:143]
    v_mul_f32 v148, v148, v212
    v_mul_f32 v149, v149, v213
    v_mul_f32 v150, v150, v214
    v_mul_f32 v151, v151, v215
    ds_read_b128 v[164:167], v15 offset:1024
    s_waitcnt lgkmcnt(3)
    v_mfma_f32_32x32x16_bf16 v[128:143], v[168:171], v[120:123], v[128:143]
    v_cvt_pk_bf16_f32 v224, v144, v145
    v_cvt_pk_bf16_f32 v225, v146, v147
    v_cvt_pk_bf16_f32 v226, v148, v149
    v_cvt_pk_bf16_f32 v227, v150, v151
    ds_read_b128 v[168:171], v15 offset:2048
    s_waitcnt lgkmcnt(3)
    v_mfma_f32_32x32x16_bf16 v[128:143], v[172:175], v[124:127], v[128:143]
    buffer_store_dwordx4 v[224:227], v6, s[8:11], s41 offen offset:2048 sc1
    s_add_u32 s41, s41, 4096
    s_cmp_lg_u32 s19, 0
    s_cbranch_scc1 L_k3_p1
    ds_read_b128 v[172:175], v15 offset:3072
    s_waitcnt lgkmcnt(3)
    v_mfma_f32_32x32x16_bf16 v[144:159], v[160:163], v[16:19], 0
    ds_read_b128 v[176:179], v12 offset:512
    ds_read_b128 v[180:183], v12 offset:528
    ds_read_b128 v[184:187], v12 offset:544
    ds_read_b128 v[188:191], v12 offset:560
    ds_read_b128 v[160:163], v15 offset:4096
    s_waitcnt lgkmcnt(7)
    v_mfma_f32_32x32x16_bf16 v[144:159], v[164:167], v[20:23], v[144:159]
    ds_read_b128 v[164:167], v15 offset:5120
    s_waitcnt lgkmcnt(7)
    v_mfma_f32_32x32x16_bf16 v[144:159], v[168:171], v[24:27], v[144:159]
    s_waitcnt lgkmcnt(2)
    v_fma_f32 v128, v8, v176, v128
    v_fma_f32 v129, v8, v177, v129
    v_fma_f32 v130, v8, v178, v130
    v_fma_f32 v131, v8, v179, v131
    ds_read_b128 v[168:171], v15 offset:6144
    s_waitcnt lgkmcnt(7)
    v_mfma_f32_32x32x16_bf16 v[144:159], v[172:175], v[28:31], v[144:159]
    v_fma_f32 v132, v8, v180, v132
    v_fma_f32 v133, v8, v181, v133
    v_fma_f32 v134, v8, v182, v134
    v_fma_f32 v135, v8, v183, v135
    ds_read_b128 v[172:175], v15 offset:7168
    s_waitcnt lgkmcnt(3)
    v_mfma_f32_32x32x16_bf16 v[144:159], v[160:163], v[32:35], v[144:159]
    v_fma_f32 v136, v8, v184, v136
    v_fma_f32 v137, v8, v185, v137
    v_fma_f32 v138, v8, v186, v138
    v_fma_f32 v139, v8, v187, v139
    ds_read_b128 v[160:163], v15 offset:8192
    s_waitcnt lgkmcnt(3)
    v_mfma_f32_32x32x16_bf16 v[144:159], v[164:167], v[36:39], v[144:159]
    v_fma_f32 v140, v8, v188, v140
    v_fma_f32 v141, v8, v189, v141
    v_fma_f32 v142, v8, v190, v142
    v_fma_f32 v143, v8, v191, v143
    ds_read_b128 v[164:167], v15 offset:9216
    s_waitcnt lgkmcnt(3)
    v_mfma_f32_32x32x16_bf16 v[144:159], v[168:171], v[40:43], v[144:159]
    v_mul_f32 v128, v9, v128
    v_mul_f32 v129, v9, v129
    v_mul_f32 v130, v9, v130
    v_mul_f32 v131, v9, v131
    ds_read_b128 v[168:171], v15 offset:10240
    s_waitcnt lgkmcnt(3)
    v_mfma_f32_32x32x16_bf16 v[144:159], v[172:175], v[44:47], v[144:159]
    v_mul_f32 v132, v9, v132
    v_mul_f32 v133, v9, v133
    v_mul_f32 v134, v9, v134
    v_mul_f32 v135, v9, v135
    ds_read_b128 v[172:175], v15 offset:11264
    s_waitcnt lgkmcnt(3)
    v_mfma_f32_32x32x16_bf16 v[144:159], v[160:163], v[48:51], v[144:159]
    v_mul_f32 v136, v9, v136
    v_mul_f32 v137, v9, v137
    v_mul_f32 v138, v9, v138
    v_mul_f32 v139, v9, v139
    ds_read_b128 v[160:163], v15 offset:12288
    s_waitcnt lgkmcnt(3)
    v_mfma_f32_32x32x16_bf16 v[144:159], v[164:167], v[52:55], v[144:159]
    v_mul_f32 v140, v9, v140
    v_mul_f32 v141, v9, v141
    v_mul_f32 v142, v9, v142
    v_mul_f32 v143, v9, v143
    ds_read_b128 v[164:167], v15 offset:13312
    s_waitcnt lgkmcnt(3)
    v_mfma_f32_32x32x16_bf16 v[144:159], v[168:171], v[56:59], v[144:159]
    v_mul_f32 v208, v128, v128
    v_mul_f32 v209, v129, v129
    v_mul_f32 v210, v130, v130
    v_mul_f32 v211, v131, v131
    ds_read_b128 v[168:171], v15 offset:14336
    s_waitcnt lgkmcnt(3)
    v_mfma_f32_32x32x16_bf16 v[144:159], v[172:175], v[60:63], v[144:159]
    v_mul_f32 v212, v132, v132
    v_mul_f32 v213, v133, v133
    v_mul_f32 v214, v134, v134
    v_mul_f32 v215, v135, v135
    ds_read_b128 v[172:175], v15 offset:15360
    s_waitcnt lgkmcnt(3)
    v_mfma_f32_32x32x16_bf16 v[144:159], v[160:163], v[64:67], v[144:159]
    v_fma_f32 v208, v208, v3, v2
    v_fma_f32 v209, v209, v3, v2
    v_fma_f32 v210, v210, v3, v2
    v_fma_f32 v211, v211, v3, v2
    ds_read_b128 v[160:163], v15 offset:16384
    s_waitcnt lgkmcnt(3)
    v_mfma_f32_32x32x16_bf16 v[144:159], v[164:167], v[68:71], v[144:159]
    v_fma_f32 v212, v212, v3, v2
    v_fma_f32 v213, v213, v3, v2
    v_fma_f32 v214, v214, v3, v2
    v_fma_f32 v215, v215, v3, v2
    ds_read_b128 v[164:167], v15 offset:17408
    s_waitcnt lgkmcnt(3)
    v_mfma_f32_32x32x16_bf16 v[144:159], v[168:171], v[72:75], v[144:159]
    v_mul_f32 v208, v208, v128
    v_mul_f32 v209, v209, v129
    v_mul_f32 v210, v210, v130
    v_mul_f32 v211, v211, v131
    ds_read_b128 v[168:171], v15 offset:18432
    s_waitcnt lgkmcnt(3)
    v_mfma_f32_32x32x16_bf16 v[144:159], v[172:175], v[76:79], v[144:159]
    v_mul_f32 v212, v212, v132
    v_mul_f32 v213, v213, v133
    v_mul_f32 v214, v214, v134
    v_mul_f32 v215, v215, v135
    ds_read_b128 v[172:175], v15 offset:19456
    s_waitcnt lgkmcnt(3)
    v_mfma_f32_32x32x16_bf16 v[144:159], v[160:163], v[80:83], v[144:159]
    v_exp_f32 v208, v208
    v_exp_f32 v209, v209
    v_exp_f32 v210, v210
    v_exp_f32 v211, v211
    ds_read_b128 v[160:163], v15 offset:20480
    s_waitcnt lgkmcnt(3)
    v_mfma_f32_32x32x16_bf16 v[144:159], v[164:167], v[84:87], v[144:159]
    v_exp_f32 v212, v212
    v_exp_f32 v213, v213
    v_exp_f32 v214, v214
    v_exp_f32 v215, v215
    ds_read_b128 v[164:167], v15 offset:21504
    s_waitcnt lgkmcnt(3)
    v_mfma_f32_32x32x16_bf16 v[144:159], v[168:171], v[88:91], v[144:159]
    v_mul_f32 v128, v128, v136
    v_mul_f32 v129, v129, v137
    v_mul_f32 v130, v130, v138
    v_mul_f32 v131, v131, v139
    ds_read_b128 v[168:171], v15 offset:22528
    s_waitcnt lgkmcnt(3)
    v_mfma_f32_32x32x16_bf16 v[144:159], v[172:175], v[92:95], v[144:159]
    v_mul_f32 v132, v132, v140
    v_mul_f32 v133, v133, v141
    v_mul_f32 v134, v134, v142
    v_mul_f32 v135, v135, v143
    ds_read_b128 v[172:175], v15 offset:23552
    s_waitcnt lgkmcnt(3)
    v_mfma_f32_32x32x16_bf16 v[144:159], v[160:163], v[96:99], v[144:159]
    v_add_f32 v208, 1.0, v208
    v_add_f32 v209, 1.0, v209
    v_add_f32 v210, 1.0, v210
    v_add_f32 v211, 1.0, v211
    ds_read_b128 v[160:163], v15 offset:24576
    s_waitcnt lgkmcnt(3)
    v_mfma_f32_32x32x16_bf16 v[144:159], v[164:167], v[100:103], v[144:159]
    v_add_f32 v212, 1.0, v212
    v_add_f32 v213, 1.0, v213
    v_add_f32 v214, 1.0, v214
    v_add_f32 v215, 1.0, v215
    ds_read_b128 v[164:167], v15 offset:25600
    s_waitcnt lgkmcnt(3)
    v_mfma_f32_32x32x16_bf16 v[144:159], v[168:171], v[104:107], v[144:159]
    v_rcp_f32 v208, v208
    v_rcp_f32 v209, v209
    v_rcp_f32 v210, v210
    v_rcp_f32 v211, v211
    ds_read_b128 v[168:171], v15 offset:26624
    s_waitcnt lgkmcnt(3)
    v_mfma_f32_32x32x16_bf16 v[144:159], v[172:175], v[108:111], v[144:159]
    v_rcp_f32 v212, v212
    v_rcp_f32 v213, v213
    v_rcp_f32 v214, v214
    v_rcp_f32 v215, v215
    ds_read_b128 v[172:175], v15 offset:27648
    s_waitcnt lgkmcnt(3)
    v_mfma_f32_32x32x16_bf16 v[144:159], v[160:163], v[112:115], v[144:159]
    v_mul_f32 v128, v128, v208
    v_mul_f32 v129, v129, v209
    v_mul_f32 v130, v130, v210
    v_mul_f32 v131, v131, v211
    s_waitcnt lgkmcnt(2)
    v_mfma_f32_32x32x16_bf16 v[144:159], v[164:167], v[116:119], v[144:159]
    v_mul_f32 v132, v132, v212
    v_mul_f32 v133, v133, v213
    v_mul_f32 v134, v134, v214
    v_mul_f32 v135, v135, v215
    s_waitcnt lgkmcnt(1)
    v_mfma_f32_32x32x16_bf16 v[144:159], v[168:171], v[120:123], v[144:159]
    v_cvt_pk_bf16_f32 v224, v128, v129
    v_cvt_pk_bf16_f32 v225, v130, v131
    v_cvt_pk_bf16_f32 v226, v132, v133
    v_cvt_pk_bf16_f32 v227, v134, v135
    s_waitcnt lgkmcnt(0)
    v_mfma_f32_32x32x16_bf16 v[144:159], v[172:175], v[124:127], v[144:159]
    buffer_store_dwordx4 v[224:227], v6, s[8:11], s41 offen offset:0 sc1
    s_nop 7
    ds_read_b128 v[176:179], v12 offset:768
    ds_read_b128 v[180:183], v12 offset:784
    ds_read_b128 v[184:187], v12 offset:800
    ds_read_b128 v[188:191], v12 offset:816
    s_waitcnt lgkmcnt(0)
    v_pk_fma_f32 v[144:145], v[8:9], v[176:177], v[144:145] op_sel:[0,0,0] op_sel_hi:[0,1,1]
    v_pk_fma_f32 v[146:147], v[8:9], v[178:179], v[146:147] op_sel:[0,0,0] op_sel_hi:[0,1,1]
    v_pk_fma_f32 v[148:149], v[8:9], v[180:181], v[148:149] op_sel:[0,0,0] op_sel_hi:[0,1,1]
    v_pk_fma_f32 v[150:151], v[8:9], v[182:183], v[150:151] op_sel:[0,0,0] op_sel_hi:[0,1,1]
    v_pk_fma_f32 v[152:153], v[8:9], v[184:185], v[152:153] op_sel:[0,0,0] op_sel_hi:[0,1,1]
    v_pk_fma_f32 v[154:155], v[8:9], v[186:187], v[154:155] op_sel:[0,0,0] op_sel_hi:[0,1,1]
    v_pk_fma_f32 v[156:157], v[8:9], v[188:189], v[156:157] op_sel:[0,0,0] op_sel_hi:[0,1,1]
    v_pk_fma_f32 v[158:159], v[8:9], v[190:191], v[158:159] op_sel:[0,0,0] op_sel_hi:[0,1,1]
    v_pk_mul_f32 v[144:145], v[8:9], v[144:145] op_sel:[1,0] op_sel_hi:[1,1]
    v_pk_mul_f32 v[146:147], v[8:9], v[146:147] op_sel:[1,0] op_sel_hi:[1,1]
    v_pk_mul_f32 v[148:149], v[8:9], v[148:149] op_sel:[1,0] op_sel_hi:[1,1]
    v_pk_mul_f32 v[150:151], v[8:9], v[150:151] op_sel:[1,0] op_sel_hi:[1,1]
    v_pk_mul_f32 v[152:153], v[8:9], v[152:153] op_sel:[1,0] op_sel_hi:[1,1]
    v_pk_mul_f32 v[154:155], v[8:9], v[154:155] op_sel:[1,0] op_sel_hi:[1,1]
    v_pk_mul_f32 v[156:157], v[8:9], v[156:157] op_sel:[1,0] op_sel_hi:[1,1]
    v_pk_mul_f32 v[158:159], v[8:9], v[158:159] op_sel:[1,0] op_sel_hi:[1,1]
    v_pk_mul_f32 v[208:209], v[144:145], v[144:145]
    v_pk_mul_f32 v[210:211], v[146:147], v[146:147]
    v_pk_mul_f32 v[212:213], v[148:149], v[148:149]
    v_pk_mul_f32 v[214:215], v[150:151], v[150:151]
    v_pk_fma_f32 v[208:209], v[208:209], v[2:3], v[2:3] op_sel:[0,1,0] op_sel_hi:[1,1,0]
    v_pk_fma_f32 v[210:211], v[210:211], v[2:3], v[2:3] op_sel:[0,1,0] op_sel_hi:[1,1,0]
    v_pk_fma_f32 v[212:213], v[212:213], v[2:3], v[2:3] op_sel:[0,1,0] op_sel_hi:[1,1,0]
    v_pk_fma_f32 v[214:215], v[214:215], v[2:3], v[2:3] op_sel:[0,1,0] op_sel_hi:[1,1,0]
    v_pk_mul_f32 v[208:209], v[208:209], v[144:145]
    v_pk_mul_f32 v[210:211], v[210:211], v[146:147]
    v_pk_mul_f32 v[212:213], v[212:213], v[148:149]
    v_pk_mul_f32 v[214:215], v[214:215], v[150:151]
    v_exp_f32 v208, v208
    v_exp_f32 v209, v209
    v_exp_f32 v210, v210
    v_exp_f32 v211, v211
    v_exp_f32 v212, v212
    v_exp_f32 v213, v213
    v_exp_f32 v214, v214
    v_exp_f32 v215, v215
    v_pk_mul_f32 v[144:145], v[144:145], v[152:153]
    v_pk_mul_f32 v[146:147], v[146:147], v[154:155]
    v_pk_mul_f32 v[148:149], v[148:149], v[156:157]
    v_pk_mul_f32 v[150:151], v[150:151], v[158:159]
    v_add_f32 v208, 1.0, v208
    v_add_f32 v209, 1.0, v209
    v_add_f32 v210, 1.0, v210
    v_add_f32 v211, 1.0, v211
    v_add_f32 v212, 1.0, v212
    v_add_f32 v213, 1.0, v213
    v_add_f32 v214, 1.0, v214
    v_add_f32 v215, 1.0, v215
    v_rcp_f32 v208, v208
    v_rcp_f32 v209, v209
    v_rcp_f32 v210, v210
    v_rcp_f32 v211, v211
    v_rcp_f32 v212, v212
    v_rcp_f32 v213, v213
    v_rcp_f32 v214, v214
    v_rcp_f32 v215, v215
    v_pk_mul_f32 v[144:145], v[144:145], v[208:209]
    v_pk_mul_f32 v[146:147], v[146:147], v[210:211]
    v_pk_mul_f32 v[148:149], v[148:149], v[212:213]
    v_pk_mul_f32 v[150:151], v[150:151], v[214:215]
    v_cvt_pk_bf16_f32 v224, v144, v145
    v_cvt_pk_bf16_f32 v225, v146, v147
    v_cvt_pk_bf16_f32 v226, v148, v149
    v_cvt_pk_bf16_f32 v227, v150, v151
    buffer_store_dwordx4 v[224:227], v6, s[8:11], s41 offen offset:2048 sc1
    s_add_u32 s41, s41, 4096
    s_endpgm
L_k3_p1:
    s_lshr_b32 s33, s2, 3
    s_lshl_b32 s33, s33, 2
    s_add_u32 s33, s33, s18
    s_mul_i32 s33, s33, 12544
    s_add_u32 s33, s33, 12582912
    s_add_u32 s33, s33, 4096
    s_add_u32 s33, s33, 4096
    s_add_u32 s33, s33, 4096
    s_mov_b32 exec_hi, 0
    s_mov_b32 exec_lo, 0xffff
    s_mov_b64 exec, -1
    s_nop 7
    ds_read_b128 v[176:179], v12 offset:512
    ds_read_b128 v[180:183], v12 offset:528
    ds_read_b128 v[184:187], v12 offset:544
    ds_read_b128 v[188:191], v12 offset:560
    s_waitcnt lgkmcnt(0)
    v_pk_fma_f32 v[128:129], v[8:9], v[176:177], v[128:129] op_sel:[0,0,0] op_sel_hi:[0,1,1]
    v_pk_fma_f32 v[130:131], v[8:9], v[178:179], v[130:131] op_sel:[0,0,0] op_sel_hi:[0,1,1]
    v_pk_fma_f32 v[132:133], v[8:9], v[180:181], v[132:133] op_sel:[0,0,0] op_sel_hi:[0,1,1]
    v_pk_fma_f32 v[134:135], v[8:9], v[182:183], v[134:135] op_sel:[0,0,0] op_sel_hi:[0,1,1]
    v_pk_fma_f32 v[136:137], v[8:9], v[184:185], v[136:137] op_sel:[0,0,0] op_sel_hi:[0,1,1]
    v_pk_fma_f32 v[138:139], v[8:9], v[186:187], v[138:139] op_sel:[0,0,0] op_sel_hi:[0,1,1]
    v_pk_fma_f32 v[140:141], v[8:9], v[188:189], v[140:141] op_sel:[0,0,0] op_sel_hi:[0,1,1]
    v_pk_fma_f32 v[142:143], v[8:9], v[190:191], v[142:143] op_sel:[0,0,0] op_sel_hi:[0,1,1]
    v_pk_mul_f32 v[128:129], v[8:9], v[128:129] op_sel:[1,0] op_sel_hi:[1,1]
    v_pk_mul_f32 v[130:131], v[8:9], v[130:131] op_sel:[1,0] op_sel_hi:[1,1]
    v_pk_mul_f32 v[132:133], v[8:9], v[132:133] op_sel:[1,0] op_sel_hi:[1,1]
    v_pk_mul_f32 v[134:135], v[8:9], v[134:135] op_sel:[1,0] op_sel_hi:[1,1]
    v_pk_mul_f32 v[136:137], v[8:9], v[136:137] op_sel:[1,0] op_sel_hi:[1,1]
    v_pk_mul_f32 v[138:139], v[8:9], v[138:139] op_sel:[1,0] op_sel_hi:[1,1]
    v_pk_mul_f32 v[140:141], v[8:9], v[140:141] op_sel:[1,0] op_sel_hi:[1,1]
    v_pk_mul_f32 v[142:143], v[8:9], v[142:143] op_sel:[1,0] op_sel_hi:[1,1]
    v_pk_mul_f32 v[208:209], v[128:129], v[128:129]
    v_pk_mul_f32 v[210:211], v[130:131], v[130:131]
    v_pk_mul_f32 v[212:213], v[132:133], v[132:133]
    v_pk_mul_f32 v[214:215], v[134:135], v[134:135]
    v_pk_fma_f32 v[208:209], v[208:209], v[2:3], v[2:3] op_sel:[0,1,0] op_sel_hi:[1,1,0]
    v_pk_fma_f32 v[210:211], v[210:211], v[2:3], v[2:3] op_sel:[0,1,0] op_sel_hi:[1,1,0]
    v_pk_fma_f32 v[212:213], v[212:213], v[2:3], v[2:3] op_sel:[0,1,0] op_sel_hi:[1,1,0]
    v_pk_fma_f32 v[214:215], v[214:215], v[2:3], v[2:3] op_sel:[0,1,0] op_sel_hi:[1,1,0]
    v_pk_mul_f32 v[208:209], v[208:209], v[128:129]
    v_pk_mul_f32 v[210:211], v[210:211], v[130:131]
    v_pk_mul_f32 v[212:213], v[212:213], v[132:133]
    v_pk_mul_f32 v[214:215], v[214:215], v[134:135]
    v_exp_f32 v208, v208
    v_exp_f32 v209, v209
    v_exp_f32 v210, v210
    v_exp_f32 v211, v211
    v_exp_f32 v212, v212
    v_exp_f32 v213, v213
    v_exp_f32 v214, v214
    v_exp_f32 v215, v215
    v_pk_mul_f32 v[128:129], v[128:129], v[136:137]
    v_pk_mul_f32 v[130:131], v[130:131], v[138:139]
    v_pk_mul_f32 v[132:133], v[132:133], v[140:141]
    v_pk_mul_f32 v[134:135], v[134:135], v[142:143]
    v_add_f32 v208, 1.0, v208
    v_add_f32 v209, 1.0, v209
    v_add_f32 v210, 1.0, v210
    v_add_f32 v211, 1.0, v211
    v_add_f32 v212, 1.0, v212
    v_add_f32 v213, 1.0, v213
    v_add_f32 v214, 1.0, v214
    v_add_f32 v215, 1.0, v215
    v_rcp_f32 v208, v208
    v_rcp_f32 v209, v209
    v_rcp_f32 v210, v210
    v_rcp_f32 v211, v211
    v_rcp_f32 v212, v212
    v_rcp_f32 v213, v213
    v_rcp_f32 v214, v214
    v_rcp_f32 v215, v215
    v_pk_mul_f32 v[128:129], v[128:129], v[208:209]
    v_pk_mul_f32 v[130:131], v[130:131], v[210:211]
    v_pk_mul_f32 v[132:133], v[132:133], v[212:213]
    v_pk_mul_f32 v[134:135], v[134:135], v[214:215]
    v_cvt_pk_bf16_f32 v224, v128, v129
    v_cvt_pk_bf16_f32 v225, v130, v131
    v_cvt_pk_bf16_f32 v226, v132, v133
    v_cvt_pk_bf16_f32 v227, v134, v135
    buffer_store_dwordx4 v[224:227], v6, s[8:11], s41 offen offset:0 sc1
    s_endpgm
L_k3_exit:
    s_endpgm
.globl k4_kernel
.p2align 8
.type k4_kernel,@function
k4_kernel:
    s_cmp_ge_u32 s2, 224
    s_cbranch_scc1 L_k4_exit
    s_load_dwordx2 s[6:7], s[0:1], 120
    s_load_dwordx2 s[4:5], s[0:1], 104
    s_and_b32 s3, s2, 7
    s_lshr_b32 s16, s2, 3
    s_and_b32 s21, s16, 3
    s_lshl_b32 s3, s3, 2
    s_add_u32 s21, s21, s3
    s_lshr_b32 s22, s16, 2
    v_and_b32 v1, 63, v0
    v_lshrrev_b32 v2, 6, v0
    s_nop 0
    v_readfirstlane_b32 s20, v2
    v_lshlrev_b32 v6, 4, v1
    s_waitcnt lgkmcnt(0)
    s_mov_b32 s8, s6
    s_and_b32 s9, s7, 0xffff
    s_mov_b32 s10, 0x1900000
    s_mov_b32 s11, 0x20000
    s_mov_b32 s12, s4
    s_and_b32 s13, s5, 0xffff
    s_mov_b32 s14, 0x1c0000
    s_mov_b32 s15, 0x20000
    v_and_b32 v3, 31, v1
    v_mul_u32_u24 v3, 896, v3
    v_lshrrev_b32 v4, 5, v1
    v_lshl_add_u32 v3, v4, 5, v3
    s_lshr_b32 s23, s20, 1
    s_lshl_b32 s24, s21, 1
    s_add_u32 s24, s24, s23
    s_mul_i32 s24, s24, 28672
    s_and_b32 s23, s20, 1
    s_lshl_b32 s25, s22, 1
    s_add_u32 s25, s25, s23
    s_lshl_b32 s25, s25, 6
    s_add_u32 s24, s24, s25
    s_lshr_b32 s23, s20, 1
    s_lshl_b32 s25, s21, 1
    s_add_u32 s25, s25, s23
    s_mul_i32 s25, s25, 28672
    s_and_b32 s23, s20, 1
    s_lshl_b32 s32, s22, 1
    s_add_u32 s32, s32, s23
    s_lshl_b32 s32, s32, 11
    s_add_u32 s25, s25, s32
    s_add_u32 s25, s25, 14680064
    s_lshl_b32 s33, s20, 11
    s_add_u32 s33, s33, 65536
    s_mov_b32 m0, s33
    s_nop 0
    buffer_load_dwordx4 v6, s[8:11], s25 offen lds
    buffer_load_dwordx4 v6, s[8:11], s25 offen offset:1024 lds
    v_and_b32 v16, 15, v1
    v_lshrrev_b32 v17, 2, v16
    v_lshlrev_b32 v17, 6, v17
    v_bfe_u32 v18, v1, 4, 1
    v_lshl_add_u32 v17, v18, 5, v17
    v_and_b32 v18, 3, v1
    v_lshl_add_u32 v17, v18, 3, v17
    v_lshrrev_b32 v18, 5, v1
    v_lshl_add_u32 v17, v18, 10, v17
    v_add_u32 v17, s33, v17
    s_mul_i32 s26, s20, 28
    s_mul_i32 s27, s22, 224
    s_add_u32 s27, s27, s26
    s_lshl_b32 s27, s27, 10
    s_add_u32 s28, s27, 12582912
    s_add_u32 s29, s28, 114688
    s_mul_i32 s27, s21, 224
    s_add_u32 s27, s27, s26
    s_lshl_b32 s27, s27, 10
    s_add_u32 s30, s27, 18874368
    s_add_u32 s31, s30, 114688
    buffer_load_dwordx4 v[104:107], v6, s[8:11], s30 offen offset:0
    buffer_load_dwordx4 v[96:99], v6, s[8:11], s28 offen offset:0
    buffer_load_dwordx4 v[108:111], v6, s[8:11], s31 offen offset:0
    buffer_load_dwordx4 v[100:103], v6, s[8:11], s29 offen offset:0
    buffer_load_dwordx4 v[120:123], v6, s[8:11], s30 offen offset:1024
    buffer_load_dwordx4 v[112:115], v6, s[8:11], s28 offen offset:1024
    buffer_load_dwordx4 v[124:127], v6, s[8:11], s31 offen offset:1024
    buffer_load_dwordx4 v[116:119], v6, s[8:11], s29 offen offset:1024
    buffer_load_dwordx4 v[136:139], v6, s[8:11], s30 offen offset:2048
    buffer_load_dwordx4 v[128:131], v6, s[8:11], s28 offen offset:2048
    buffer_load_dwordx4 v[140:143], v6, s[8:11], s31 offen offset:2048
    buffer_load_dwordx4 v[132:135], v6, s[8:11], s29 offen offset:2048
    buffer_load_dwordx4 v[152:155], v6, s[8:11], s30 offen offset:3072
    buffer_load_dwordx4 v[144:147], v6, s[8:11], s28 offen offset:3072
    buffer_load_dwordx4 v[156:159], v6, s[8:11], s31 offen offset:3072
    buffer_load_dwordx4 v[148:151], v6, s[8:11], s29 offen offset:3072
    s_add_u32 s28, s28, 4096
    s_add_u32 s29, s29, 4096
    s_add_u32 s30, s30, 4096
    s_add_u32 s31, s31, 4096
    buffer_load_dwordx4 v[168:171], v6, s[8:11], s30 offen offset:0
    buffer_load_dwordx4 v[160:163], v6, s[8:11], s28 offen offset:0
    buffer_load_dwordx4 v[172:175], v6, s[8:11], s31 offen offset:0
    buffer_load_dwordx4 v[164:167], v6, s[8:11], s29 offen offset:0
    s_waitcnt vmcnt(18)
    v_mfma_f32_32x32x16_bf16 v[32:47], v[96:99], v[104:107], 0
    s_waitcnt vmcnt(17)
    v_mfma_f32_32x32x16_bf16 v[64:79], v[96:99], v[108:111], 0
    s_waitcnt vmcnt(16)
    v_mfma_f32_32x32x16_bf16 v[48:63], v[100:103], v[104:107], 0
    v_mfma_f32_32x32x16_bf16 v[80:95], v[100:103], v[108:111], 0
    buffer_load_dwordx4 v[104:107], v6, s[8:11], s30 offen offset:1024
    buffer_load_dwordx4 v[96:99], v6, s[8:11], s28 offen offset:1024
    buffer_load_dwordx4 v[108:111], v6, s[8:11], s31 offen offset:1024
    buffer_load_dwordx4 v[100:103], v6, s[8:11], s29 offen offset:1024
    s_waitcnt vmcnt(18)
    v_mfma_f32_32x32x16_bf16 v[32:47], v[112:115], v[120:123], v[32:47]
    s_waitcnt vmcnt(17)
    v_mfma_f32_32x32x16_bf16 v[64:79], v[112:115], v[124:127], v[64:79]
    s_waitcnt vmcnt(16)
    v_mfma_f32_32x32x16_bf16 v[48:63], v[116:119], v[120:123], v[48:63]
    v_mfma_f32_32x32x16_bf16 v[80:95], v[116:119], v[124:127], v[80:95]
    buffer_load_dwordx4 v[120:123], v6, s[8:11], s30 offen offset:2048
    buffer_load_dwordx4 v[112:115], v6, s[8:11], s28 offen offset:2048
    buffer_load_dwordx4 v[124:127], v6, s[8:11], s31 offen offset:2048
    buffer_load_dwordx4 v[116:119], v6, s[8:11], s29 offen offset:2048
    s_waitcnt vmcnt(18)
    v_mfma_f32_32x32x16_bf16 v[32:47], v[128:131], v[136:139], v[32:47]
    s_waitcnt vmcnt(17)
    v_mfma_f32_32x32x16_bf16 v[64:79], v[128:131], v[140:143], v[64:79]
    s_waitcnt vmcnt(16)
    v_mfma_f32_32x32x16_bf16 v[48:63], v[132:135], v[136:139], v[48:63]
    v_mfma_f32_32x32x16_bf16 v[80:95], v[132:135], v[140:143], v[80:95]
    buffer_load_dwordx4 v[136:139], v6, s[8:11], s30 offen offset:3072
    buffer_load_dwordx4 v[128:131], v6, s[8:11], s28 offen offset:3072
    buffer_load_dwordx4 v[140:143], v6, s[8:11], s31 offen offset:3072
    buffer_load_dwordx4 v[132:135], v6, s[8:11], s29 offen offset:3072
    s_add_u32 s28, s28, 4096
    s_add_u32 s29, s29, 4096
    s_add_u32 s30, s30, 4096
    s_add_u32 s31, s31, 4096
    s_waitcnt vmcnt(18)
    v_mfma_f32_32x32x16_bf16 v[32:47], v[144:147], v[152:155], v[32:47]
    s_waitcnt vmcnt(17)
    v_mfma_f32_32x32x16_bf16 v[64:79], v[144:147], v[156:159], v[64:79]
    s_waitcnt vmcnt(16)
    v_mfma_f32_32x32x16_bf16 v[48:63], v[148:151], v[152:155], v[48:63]
    v_mfma_f32_32x32x16_bf16 v[80:95], v[148:151], v[156:159], v[80:95]
    buffer_load_dwordx4 v[152:155], v6, s[8:11], s30 offen offset:0
    buffer_load_dwordx4 v[144:147], v6, s[8:11], s28 offen offset:0
    buffer_load_dwordx4 v[156:159], v6, s[8:11], s31 offen offset:0
    buffer_load_dwordx4 v[148:151], v6, s[8:11], s29 offen offset:0
    s_waitcnt vmcnt(18)
    v_mfma_f32_32x32x16_bf16 v[32:47], v[160:163], v[168:171], v[32:47]
    s_waitcnt vmcnt(17)
    v_mfma_f32_32x32x16_bf16 v[64:79], v[160:163], v[172:175], v[64:79]
    s_waitcnt vmcnt(16)
    v_mfma_f32_32x32x16_bf16 v[48:63], v[164:167], v[168:171], v[48:63]
    v_mfma_f32_32x32x16_bf16 v[80:95], v[164:167], v[172:175], v[80:95]
    buffer_load_dwordx4 v[168:171], v6, s[8:11], s30 offen offset:1024
    buffer_load_dwordx4 v[160:163], v6, s[8:11], s28 offen offset:1024
    buffer_load_dwordx4 v[172:175], v6, s[8:11], s31 offen offset:1024
    buffer_load_dwordx4 v[164:167], v6, s[8:11], s29 offen offset:1024
    s_waitcnt vmcnt(18)
    v_mfma_f32_32x32x16_bf16 v[32:47], v[96:99], v[104:107], v[32:47]
    s_waitcnt vmcnt(17)
    v_mfma_f32_32x32x16_bf16 v[64:79], v[96:99], v[108:111], v[64:79]
    s_waitcnt vmcnt(16)
    v_mfma_f32_32x32x16_bf16 v[48:63], v[100:103], v[104:107], v[48:63]
    v_mfma_f32_32x32x16_bf16 v[80:95], v[100:103], v[108:111], v[80:95]
    buffer_load_dwordx4 v[104:107], v6, s[8:11], s30 offen offset:2048
    buffer_load_dwordx4 v[96:99], v6, s[8:11], s28 offen offset:2048
    buffer_load_dwordx4 v[108:111], v6, s[8:11], s31 offen offset:2048
    buffer_load_dwordx4 v[100:103], v6, s[8:11], s29 offen offset:2048
    s_waitcnt vmcnt(18)
    v_mfma_f32_32x32x16_bf16 v[32:47], v[112:115], v[120:123], v[32:47]
    s_waitcnt vmcnt(17)
    v_mfma_f32_32x32x16_bf16 v[64:79], v[112:115], v[124:127], v[64:79]
    s_waitcnt vmcnt(16)
    v_mfma_f32_32x32x16_bf16 v[48:63], v[116:119], v[120:123], v[48:63]
    v_mfma_f32_32x32x16_bf16 v[80:95], v[116:119], v[124:127], v[80:95]
    buffer_load_dwordx4 v[120:123], v6, s[8:11], s30 offen offset:3072
    buffer_load_dwordx4 v[112:115], v6, s[8:11], s28 offen offset:3072
    buffer_load_dwordx4 v[124:127], v6, s[8:11], s31 offen offset:3072
    buffer_load_dwordx4 v[116:119], v6, s[8:11], s29 offen offset:3072
    s_add_u32 s28, s28, 4096
    s_add_u32 s29, s29, 4096
    s_add_u32 s30, s30, 4096
    s_add_u32 s31, s31, 4096
    s_waitcnt vmcnt(18)
    v_mfma_f32_32x32x16_bf16 v[32:47], v[128:131], v[136:139], v[32:47]
    s_waitcnt vmcnt(17)
    v_mfma_f32_32x32x16_bf16 v[64:79], v[128:131], v[140:143], v[64:79]
    s_waitcnt vmcnt(16)
    v_mfma_f32_32x32x16_bf16 v[48:63], v[132:135], v[136:139], v[48:63]
    v_mfma_f32_32x32x16_bf16 v[80:95], v[132:135], v[140:143], v[80:95]
    buffer_load_dwordx4 v[136:139], v6, s[8:11], s30 offen offset:0
    buffer_load_dwordx4 v[128:131], v6, s[8:11], s28 offen offset:0
    buffer_load_dwordx4 v[140:143], v6, s[8:11], s31 offen offset:0
    buffer_load_dwordx4 v[132:135], v6, s[8:11], s29 offen offset:0
    s_waitcnt vmcnt(18)
    v_mfma_f32_32x32x16_bf16 v[32:47], v[144:147], v[152:155], v[32:47]
    s_waitcnt vmcnt(17)
    v_mfma_f32_32x32x16_bf16 v[64:79], v[144:147], v[156:159], v[64:79]
    s_waitcnt vmcnt(16)
    v_mfma_f32_32x32x16_bf16 v[48:63], v[148:151], v[152:155], v[48:63]
    v_mfma_f32_32x32x16_bf16 v[80:95], v[148:151], v[156:159], v[80:95]
    buffer_load_dwordx4 v[152:155], v6, s[8:11], s30 offen offset:1024
    buffer_load_dwordx4 v[144:147], v6, s[8:11], s28 offen offset:1024
    buffer_load_dwordx4 v[156:159], v6, s[8:11], s31 offen offset:1024
    buffer_load_dwordx4 v[148:151], v6, s[8:11], s29 offen offset:1024
    s_waitcnt vmcnt(18)
    v_mfma_f32_32x32x16_bf16 v[32:47], v[160:163], v[168:171], v[32:47]
    s_waitcnt vmcnt(17)
    v_mfma_f32_32x32x16_bf16 v[64:79], v[160:163], v[172:175], v[64:79]
    s_waitcnt vmcnt(16)
    v_mfma_f32_32x32x16_bf16 v[48:63], v[164:167], v[168:171], v[48:63]
    v_mfma_f32_32x32x16_bf16 v[80:95], v[164:167], v[172:175], v[80:95]
    buffer_load_dwordx4 v[168:171], v6, s[8:11], s30 offen offset:2048
    buffer_load_dwordx4 v[160:163], v6, s[8:11], s28 offen offset:2048
    buffer_load_dwordx4 v[172:175], v6, s[8:11], s31 offen offset:2048
    buffer_load_dwordx4 v[164:167], v6, s[8:11], s29 offen offset:2048
    s_waitcnt vmcnt(18)
    v_mfma_f32_32x32x16_bf16 v[32:47], v[96:99], v[104:107], v[32:47]
    s_waitcnt vmcnt(17)
    v_mfma_f32_32x32x16_bf16 v[64:79], v[96:99], v[108:111], v[64:79]
    s_waitcnt vmcnt(16)
    v_mfma_f32_32x32x16_bf16 v[48:63], v[100:103], v[104:107], v[48:63]
    v_mfma_f32_32x32x16_bf16 v[80:95], v[100:103], v[108:111], v[80:95]
    buffer_load_dwordx4 v[104:107], v6, s[8:11], s30 offen offset:3072
    buffer_load_dwordx4 v[96:99], v6, s[8:11], s28 offen offset:3072
    buffer_load_dwordx4 v[108:111], v6, s[8:11], s31 offen offset:3072
    buffer_load_dwordx4 v[100:103], v6, s[8:11], s29 offen offset:3072
    s_add_u32 s28, s28, 4096
    s_add_u32 s29, s29, 4096
    s_add_u32 s30, s30, 4096
    s_add_u32 s31, s31, 4096
    s_waitcnt vmcnt(18)
    v_mfma_f32_32x32x16_bf16 v[32:47], v[112:115], v[120:123], v[32:47]
    s_waitcnt vmcnt(17)
    v_mfma_f32_32x32x16_bf16 v[64:79], v[112:115], v[124:127], v[64:79]
    s_waitcnt vmcnt(16)
    v_mfma_f32_32x32x16_bf16 v[48:63], v[116:119], v[120:123], v[48:63]
    v_mfma_f32_32x32x16_bf16 v[80:95], v[116:119], v[124:127], v[80:95]
    buffer_load_dwordx4 v[120:123], v6, s[8:11], s30 offen offset:0
    buffer_load_dwordx4 v[112:115], v6, s[8:11], s28 offen offset:0
    buffer_load_dwordx4 v[124:127], v6, s[8:11], s31 offen offset:0
    buffer_load_dwordx4 v[116:119], v6, s[8:11], s29 offen offset:0
    s_waitcnt vmcnt(18)
    v_mfma_f32_32x32x16_bf16 v[32:47], v[128:131], v[136:139], v[32:47]
    s_waitcnt vmcnt(17)
    v_mfma_f32_32x32x16_bf16 v[64:79], v[128:131], v[140:143], v[64:79]
    s_waitcnt vmcnt(16)
    v_mfma_f32_32x32x16_bf16 v[48:63], v[132:135], v[136:139], v[48:63]
    v_mfma_f32_32x32x16_bf16 v[80:95], v[132:135], v[140:143], v[80:95]
    buffer_load_dwordx4 v[136:139], v6, s[8:11], s30 offen offset:1024
    buffer_load_dwordx4 v[128:131], v6, s[8:11], s28 offen offset:1024
    buffer_load_dwordx4 v[140:143], v6, s[8:11], s31 offen offset:1024
    buffer_load_dwordx4 v[132:135], v6, s[8:11], s29 offen offset:1024
    s_waitcnt vmcnt(18)
    v_mfma_f32_32x32x16_bf16 v[32:47], v[144:147], v[152:155], v[32:47]
    s_waitcnt vmcnt(17)
    v_mfma_f32_32x32x16_bf16 v[64:79], v[144:147], v[156:159], v[64:79]
    s_waitcnt vmcnt(16)
    v_mfma_f32_32x32x16_bf16 v[48:63], v[148:151], v[152:155], v[48:63]
    v_mfma_f32_32x32x16_bf16 v[80:95], v[148:151], v[156:159], v[80:95]
    buffer_load_dwordx4 v[152:155], v6, s[8:11], s30 offen offset:2048
    buffer_load_dwordx4 v[144:147], v6, s[8:11], s28 offen offset:2048
    buffer_load_dwordx4 v[156:159], v6, s[8:11], s31 offen offset:2048
    buffer_load_dwordx4 v[148:151], v6, s[8:11], s29 offen offset:2048
    s_waitcnt vmcnt(18)
    v_mfma_f32_32x32x16_bf16 v[32:47], v[160:163], v[168:171], v[32:47]
    s_waitcnt vmcnt(17)
    v_mfma_f32_32x32x16_bf16 v[64:79], v[160:163], v[172:175], v[64:79]
    s_waitcnt vmcnt(16)
    v_mfma_f32_32x32x16_bf16 v[48:63], v[164:167], v[168:171], v[48:63]
    v_mfma_f32_32x32x16_bf16 v[80:95], v[164:167], v[172:175], v[80:95]
    buffer_load_dwordx4 v[168:171], v6, s[8:11], s30 offen offset:3072
    buffer_load_dwordx4 v[160:163], v6, s[8:11], s28 offen offset:3072
    buffer_load_dwordx4 v[172:175], v6, s[8:11], s31 offen offset:3072
    buffer_load_dwordx4 v[164:167], v6, s[8:11], s29 offen offset:3072
    s_add_u32 s28, s28, 4096
    s_add_u32 s29, s29, 4096
    s_add_u32 s30, s30, 4096
    s_add_u32 s31, s31, 4096
    s_waitcnt vmcnt(18)
    v_mfma_f32_32x32x16_bf16 v[32:47], v[96:99], v[104:107], v[32:47]
    s_waitcnt vmcnt(17)
    v_mfma_f32_32x32x16_bf16 v[64:79], v[96:99], v[108:111], v[64:79]
    s_waitcnt vmcnt(16)
    v_mfma_f32_32x32x16_bf16 v[48:63], v[100:103], v[104:107], v[48:63]
    v_mfma_f32_32x32x16_bf16 v[80:95], v[100:103], v[108:111], v[80:95]
    buffer_load_dwordx4 v[104:107], v6, s[8:11], s30 offen offset:0
    buffer_load_dwordx4 v[96:99], v6, s[8:11], s28 offen offset:0
    buffer_load_dwordx4 v[108:111], v6, s[8:11], s31 offen offset:0
    buffer_load_dwordx4 v[100:103], v6, s[8:11], s29 offen offset:0
    s_waitcnt vmcnt(18)
    v_mfma_f32_32x32x16_bf16 v[32:47], v[112:115], v[120:123], v[32:47]
    s_waitcnt vmcnt(17)
    v_mfma_f32_32x32x16_bf16 v[64:79], v[112:115], v[124:127], v[64:79]
    s_waitcnt vmcnt(16)
    v_mfma_f32_32x32x16_bf16 v[48:63], v[116:119], v[120:123], v[48:63]
    v_mfma_f32_32x32x16_bf16 v[80:95], v[116:119], v[124:127], v[80:95]
    buffer_load_dwordx4 v[120:123], v6, s[8:11], s30 offen offset:1024
    buffer_load_dwordx4 v[112:115], v6, s[8:11], s28 offen offset:1024
    buffer_load_dwordx4 v[124:127], v6, s[8:11], s31 offen offset:1024
    buffer_load_dwordx4 v[116:119], v6, s[8:11], s29 offen offset:1024
    s_waitcnt vmcnt(18)
    v_mfma_f32_32x32x16_bf16 v[32:47], v[128:131], v[136:139], v[32:47]
    s_waitcnt vmcnt(17)
    v_mfma_f32_32x32x16_bf16 v[64:79], v[128:131], v[140:143], v[64:79]
    s_waitcnt vmcnt(16)
    v_mfma_f32_32x32x16_bf16 v[48:63], v[132:135], v[136:139], v[48:63]
    v_mfma_f32_32x32x16_bf16 v[80:95], v[132:135], v[140:143], v[80:95]
    buffer_load_dwordx4 v[136:139], v6, s[8:11], s30 offen offset:2048
    buffer_load_dwordx4 v[128:131], v6, s[8:11], s28 offen offset:2048
    buffer_load_dwordx4 v[140:143], v6, s[8:11], s31 offen offset:2048
    buffer_load_dwordx4 v[132:135], v6, s[8:11], s29 offen offset:2048
    s_waitcnt vmcnt(18)
    v_mfma_f32_32x32x16_bf16 v[32:47], v[144:147], v[152:155], v[32:47]
    s_waitcnt vmcnt(17)
    v_mfma_f32_32x32x16_bf16 v[64:79], v[144:147], v[156:159], v[64:79]
    s_waitcnt vmcnt(16)
    v_mfma_f32_32x32x16_bf16 v[48:63], v[148:151], v[152:155], v[48:63]
    v_mfma_f32_32x32x16_bf16 v[80:95], v[148:151], v[156:159], v[80:95]
    buffer_load_dwordx4 v[152:155], v6, s[8:11], s30 offen offset:3072
    buffer_load_dwordx4 v[144:147], v6, s[8:11], s28 offen offset:3072
    buffer_load_dwordx4 v[156:159], v6, s[8:11], s31 offen offset:3072
    buffer_load_dwordx4 v[148:151], v6, s[8:11], s29 offen offset:3072
    s_add_u32 s28, s28, 4096
    s_add_u32 s29, s29, 4096
    s_add_u32 s30, s30, 4096
    s_add_u32 s31, s31, 4096
    s_waitcnt vmcnt(18)
    v_mfma_f32_32x32x16_bf16 v[32:47], v[160:163], v[168:171], v[32:47]
    s_waitcnt vmcnt(17)
    v_mfma_f32_32x32x16_bf16 v[64:79], v[160:163], v[172:175], v[64:79]
    s_waitcnt vmcnt(16)
    v_mfma_f32_32x32x16_bf16 v[48:63], v[164:167], v[168:171], v[48:63]
    v_mfma_f32_32x32x16_bf16 v[80:95], v[164:167], v[172:175], v[80:95]
    buffer_load_dwordx4 v[168:171], v6, s[8:11], s30 offen offset:0
    buffer_load_dwordx4 v[160:163], v6, s[8:11], s28 offen offset:0
    buffer_load_dwordx4 v[172:175], v6, s[8:11], s31 offen offset:0
    buffer_load_dwordx4 v[164:167], v6, s[8:11], s29 offen offset:0
    s_waitcnt vmcnt(18)
    v_mfma_f32_32x32x16_bf16 v[32:47], v[96:99], v[104:107], v[32:47]
    s_waitcnt vmcnt(17)
    v_mfma_f32_32x32x16_bf16 v[64:79], v[96:99], v[108:111], v[64:79]
    s_waitcnt vmcnt(16)
    v_mfma_f32_32x32x16_bf16 v[48:63], v[100:103], v[104:107], v[48:63]
    v_mfma_f32_32x32x16_bf16 v[80:95], v[100:103], v[108:111], v[80:95]
    buffer_load_dwordx4 v[104:107], v6, s[8:11], s30 offen offset:1024
    buffer_load_dwordx4 v[96:99], v6, s[8:11], s28 offen offset:1024
    buffer_load_dwordx4 v[108:111], v6, s[8:11], s31 offen offset:1024
    buffer_load_dwordx4 v[100:103], v6, s[8:11], s29 offen offset:1024
    s_waitcnt vmcnt(18)
    v_mfma_f32_32x32x16_bf16 v[32:47], v[112:115], v[120:123], v[32:47]
    s_waitcnt vmcnt(17)
    v_mfma_f32_32x32x16_bf16 v[64:79], v[112:115], v[124:127], v[64:79]
    s_waitcnt vmcnt(16)
    v_mfma_f32_32x32x16_bf16 v[48:63], v[116:119], v[120:123], v[48:63]
    v_mfma_f32_32x32x16_bf16 v[80:95], v[116:119], v[124:127], v[80:95]
    buffer_load_dwordx4 v[120:123], v6, s[8:11], s30 offen offset:2048
    buffer_load_dwordx4 v[112:115], v6, s[8:11], s28 offen offset:2048
    buffer_load_dwordx4 v[124:127], v6, s[8:11], s31 offen offset:2048
    buffer_load_dwordx4 v[116:119], v6, s[8:11], s29 offen offset:2048
    s_waitcnt vmcnt(18)
    v_mfma_f32_32x32x16_bf16 v[32:47], v[128:131], v[136:139], v[32:47]
    s_waitcnt vmcnt(17)
    v_mfma_f32_32x32x16_bf16 v[64:79], v[128:131], v[140:143], v[64:79]
    s_waitcnt vmcnt(16)
    v_mfma_f32_32x32x16_bf16 v[48:63], v[132:135], v[136:139], v[48:63]
    v_mfma_f32_32x32x16_bf16 v[80:95], v[132:135], v[140:143], v[80:95]
    buffer_load_dwordx4 v[136:139], v6, s[8:11], s30 offen offset:3072
    buffer_load_dwordx4 v[128:131], v6, s[8:11], s28 offen offset:3072
    buffer_load_dwordx4 v[140:143], v6, s[8:11], s31 offen offset:3072
    buffer_load_dwordx4 v[132:135], v6, s[8:11], s29 offen offset:3072
    s_add_u32 s28, s28, 4096
    s_add_u32 s29, s29, 4096
    s_add_u32 s30, s30, 4096
    s_add_u32 s31, s31, 4096
    s_waitcnt vmcnt(18)
    v_mfma_f32_32x32x16_bf16 v[32:47], v[144:147], v[152:155], v[32:47]
    s_waitcnt vmcnt(17)
    v_mfma_f32_32x32x16_bf16 v[64:79], v[144:147], v[156:159], v[64:79]
    s_waitcnt vmcnt(16)
    v_mfma_f32_32x32x16_bf16 v[48:63], v[148:151], v[152:155], v[48:63]
    v_mfma_f32_32x32x16_bf16 v[80:95], v[148:151], v[156:159], v[80:95]
    s_waitcnt vmcnt(14)
    v_mfma_f32_32x32x16_bf16 v[32:47], v[160:163], v[168:171], v[32:47]
    s_waitcnt vmcnt(13)
    v_mfma_f32_32x32x16_bf16 v[64:79], v[160:163], v[172:175], v[64:79]
    s_waitcnt vmcnt(12)
    v_mfma_f32_32x32x16_bf16 v[48:63], v[164:167], v[168:171], v[48:63]
    v_mfma_f32_32x32x16_bf16 v[80:95], v[164:167], v[172:175], v[80:95]
    s_waitcnt vmcnt(10)
    v_mfma_f32_32x32x16_bf16 v[32:47], v[96:99], v[104:107], v[32:47]
    s_waitcnt vmcnt(9)
    v_mfma_f32_32x32x16_bf16 v[64:79], v[96:99], v[108:111], v[64:79]
    s_waitcnt vmcnt(8)
    v_mfma_f32_32x32x16_bf16 v[48:63], v[100:103], v[104:107], v[48:63]
    v_mfma_f32_32x32x16_bf16 v[80:95], v[100:103], v[108:111], v[80:95]
    s_waitcnt vmcnt(6)
    v_mfma_f32_32x32x16_bf16 v[32:47], v[112:115], v[120:123], v[32:47]
    s_waitcnt vmcnt(5)
    v_mfma_f32_32x32x16_bf16 v[64:79], v[112:115], v[124:127], v[64:79]
    s_waitcnt vmcnt(4)
    v_mfma_f32_32x32x16_bf16 v[48:63], v[116:119], v[120:123], v[48:63]
    v_mfma_f32_32x32x16_bf16 v[80:95], v[116:119], v[124:127], v[80:95]
    s_waitcnt vmcnt(2)
    v_mfma_f32_32x32x16_bf16 v[32:47], v[128:131], v[136:139], v[32:47]
    s_waitcnt vmcnt(1)
    v_mfma_f32_32x32x16_bf16 v[64:79], v[128:131], v[140:143], v[64:79]
    s_waitcnt vmcnt(0)
    v_mfma_f32_32x32x16_bf16 v[48:63], v[132:135], v[136:139], v[48:63]
    v_mfma_f32_32x32x16_bf16 v[80:95], v[132:135], v[140:143], v[80:95]
    s_lshl_b32 s26, s20, 14
    v_add_u32 v7, s26, v6
    s_nop 7
    ds_write_b128 v7, v[32:35] offset:0
    ds_write_b128 v7, v[36:39] offset:1024
    ds_write_b128 v7, v[40:43] offset:2048
    ds_write_b128 v7, v[44:47] offset:3072
    ds_write_b128 v7, v[48:51] offset:4096
    ds_write_b128 v7, v[52:55] offset:5120
    ds_write_b128 v7, v[56:59] offset:6144
    ds_write_b128 v7, v[60:63] offset:7168
    ds_write_b128 v7, v[64:67] offset:8192
    ds_write_b128 v7, v[68:71] offset:9216
    ds_write_b128 v7, v[72:75] offset:10240
    ds_write_b128 v7, v[76:79] offset:11264
    ds_write_b128 v7, v[80:83] offset:12288
    ds_write_b128 v7, v[84:87] offset:13312
    ds_write_b128 v7, v[88:91] offset:14336
    ds_write_b128 v7, v[92:95] offset:15360
    s_waitcnt lgkmcnt(0)
    s_barrier
    s_lshl_b32 s26, s20, 12
    v_add_u32 v7, s26, v6
    ds_read_b128 v[32:35], v7 offset:0
    ds_read_b128 v[36:39], v7 offset:1024
    ds_read_b128 v[40:43], v7 offset:2048
    ds_read_b128 v[44:47], v7 offset:3072
    ds_read_b128 v[48:51], v7 offset:16384
    ds_read_b128 v[52:55], v7 offset:17408
    ds_read_b128 v[56:59], v7 offset:18432
    ds_read_b128 v[60:63], v7 offset:19456
    ds_read_b128 v[64:67], v7 offset:32768
    ds_read_b128 v[68:71], v7 offset:33792
    ds_read_b128 v[72:75], v7 offset:34816
    ds_read_b128 v[76:79], v7 offset:35840
    ds_read_b128 v[80:83], v7 offset:49152
    ds_read_b128 v[84:87], v7 offset:50176
    ds_read_b128 v[88:91], v7 offset:51200
    ds_read_b128 v[92:95], v7 offset:52224
    ds_read_b64_tr_b16 v[8:9], v17 offset:0
    ds_read_b64_tr_b16 v[10:11], v17 offset:256
    ds_read_b64_tr_b16 v[12:13], v17 offset:512
    ds_read_b64_tr_b16 v[14:15], v17 offset:768
    s_waitcnt lgkmcnt(0)
    v_add_f32 v32, v32, v48
    v_add_f32 v64, v64, v80
    v_add_f32 v33, v33, v49
    v_add_f32 v65, v65, v81
    v_add_f32 v34, v34, v50
    v_add_f32 v66, v66, v82
    v_add_f32 v35, v35, v51
    v_add_f32 v67, v67, v83
    v_add_f32 v36, v36, v52
    v_add_f32 v68, v68, v84
    v_add_f32 v37, v37, v53
    v_add_f32 v69, v69, v85
    v_add_f32 v38, v38, v54
    v_add_f32 v70, v70, v86
    v_add_f32 v39, v39, v55
    v_add_f32 v71, v71, v87
    v_add_f32 v40, v40, v56
    v_add_f32 v72, v72, v88
    v_add_f32 v41, v41, v57
    v_add_f32 v73, v73, v89
    v_add_f32 v42, v42, v58
    v_add_f32 v74, v74, v90
    v_add_f32 v43, v43, v59
    v_add_f32 v75, v75, v91
    v_add_f32 v44, v44, v60
    v_add_f32 v76, v76, v92
    v_add_f32 v45, v45, v61
    v_add_f32 v77, v77, v93
    v_add_f32 v46, v46, v62
    v_add_f32 v78, v78, v94
    v_add_f32 v47, v47, v63
    v_add_f32 v79, v79, v95
    v_add_f32 v32, v32, v64
    v_add_f32 v33, v33, v65
    v_add_f32 v34, v34, v66
    v_add_f32 v35, v35, v67
    v_add_f32 v36, v36, v68
    v_add_f32 v37, v37, v69
    v_add_f32 v38, v38, v70
    v_add_f32 v39, v39, v71
    v_add_f32 v40, v40, v72
    v_add_f32 v41, v41, v73
    v_add_f32 v42, v42, v74
    v_add_f32 v43, v43, v75
    v_add_f32 v44, v44, v76
    v_add_f32 v45, v45, v77
    v_add_f32 v46, v46, v78
    v_add_f32 v47, v47, v79
    v_cvt_pk_bf16_f32 v48, v32, v33
    v_cvt_pk_bf16_f32 v49, v34, v35
    v_cvt_pk_bf16_f32 v50, v36, v37
    v_cvt_pk_bf16_f32 v51, v38, v39
    v_cvt_pk_bf16_f32 v52, v40, v41
    v_cvt_pk_bf16_f32 v53, v42, v43
    v_cvt_pk_bf16_f32 v54, v44, v45
    v_cvt_pk_bf16_f32 v55, v46, v47
    v_lshlrev_b32 v32, 16, v48
    v_and_b32 v33, 0xffff0000, v48
    v_lshlrev_b32 v64, 16, v8
    v_and_b32 v65, 0xffff0000, v8
    v_lshlrev_b32 v34, 16, v49
    v_and_b32 v35, 0xffff0000, v49
    v_lshlrev_b32 v66, 16, v9
    v_and_b32 v67, 0xffff0000, v9
    v_lshlrev_b32 v36, 16, v50
    v_and_b32 v37, 0xffff0000, v50
    v_lshlrev_b32 v68, 16, v10
    v_and_b32 v69, 0xffff0000, v10
    v_lshlrev_b32 v38, 16, v51
    v_and_b32 v39, 0xffff0000, v51
    v_lshlrev_b32 v70, 16, v11
    v_and_b32 v71, 0xffff0000, v11
    v_lshlrev_b32 v40, 16, v52
    v_and_b32 v41, 0xffff0000, v52
    v_lshlrev_b32 v72, 16, v12
    v_and_b32 v73, 0xffff0000, v12
    v_lshlrev_b32 v42, 16, v53
    v_and_b32 v43, 0xffff0000, v53
    v_lshlrev_b32 v74, 16, v13
    v_and_b32 v75, 0xffff0000, v13
    v_lshlrev_b32 v44, 16, v54
    v_and_b32 v45, 0xffff0000, v54
    v_lshlrev_b32 v76, 16, v14
    v_and_b32 v77, 0xffff0000, v14
    v_lshlrev_b32 v46, 16, v55
    v_and_b32 v47, 0xffff0000, v55
    v_lshlrev_b32 v78, 16, v15
    v_and_b32 v79, 0xffff0000, v15
    v_add_f32 v32, v32, v64
    v_add_f32 v33, v33, v65
    v_add_f32 v34, v34, v66
    v_add_f32 v35, v35, v67
    v_add_f32 v36, v36, v68
    v_add_f32 v37, v37, v69
    v_add_f32 v38, v38, v70
    v_add_f32 v39, v39, v71
    v_add_f32 v40, v40, v72
    v_add_f32 v41, v41, v73
    v_add_f32 v42, v42, v74
    v_add_f32 v43, v43, v75
    v_add_f32 v44, v44, v76
    v_add_f32 v45, v45, v77
    v_add_f32 v46, v46, v78
    v_add_f32 v47, v47, v79
    v_cvt_pk_bf16_f32 v48, v32, v33
    v_cvt_pk_bf16_f32 v49, v34, v35
    v_cvt_pk_bf16_f32 v50, v36, v37
    v_cvt_pk_bf16_f32 v51, v38, v39
    v_cvt_pk_bf16_f32 v52, v40, v41
    v_cvt_pk_bf16_f32 v53, v42, v43
    v_cvt_pk_bf16_f32 v54, v44, v45
    v_cvt_pk_bf16_f32 v55, v46, v47
    buffer_store_dwordx4 v[48:51], v3, s[12:15], s24 offen
    buffer_store_dwordx4 v[52:55], v3, s[12:15], s24 offen offset:16
    s_endpgm
L_k4_exit:
    s_endpgm
.section .rodata,"a"
.p2align 6
.amdhsa_kernel k1_kernel
  .amdhsa_next_free_vgpr 128
  .amdhsa_next_free_sgpr 102
  .amdhsa_accum_offset 128
  .amdhsa_group_segment_fixed_size 0
  .amdhsa_kernarg_size 128
  .amdhsa_user_sgpr_count 2
  .amdhsa_user_sgpr_kernarg_segment_ptr 1
  .amdhsa_system_sgpr_workgroup_id_x 1
.end_amdhsa_kernel
.amdhsa_kernel k2_kernel
  .amdhsa_next_free_vgpr 192
  .amdhsa_next_free_sgpr 102
  .amdhsa_accum_offset 192
  .amdhsa_group_segment_fixed_size 0
  .amdhsa_kernarg_size 128
  .amdhsa_user_sgpr_count 2
  .amdhsa_user_sgpr_kernarg_segment_ptr 1
  .amdhsa_system_sgpr_workgroup_id_x 1
.end_amdhsa_kernel
.amdhsa_kernel k3_kernel
  .amdhsa_next_free_vgpr 256
  .amdhsa_next_free_sgpr 102
  .amdhsa_accum_offset 256
  .amdhsa_group_segment_fixed_size 0
  .amdhsa_kernarg_size 128
  .amdhsa_user_sgpr_count 2
  .amdhsa_user_sgpr_kernarg_segment_ptr 1
  .amdhsa_system_sgpr_workgroup_id_x 1
.end_amdhsa_kernel
.amdhsa_kernel k4_kernel
  .amdhsa_next_free_vgpr 256
  .amdhsa_next_free_sgpr 102
  .amdhsa_accum_offset 256
  .amdhsa_group_segment_fixed_size 0
  .amdhsa_kernarg_size 128
  .amdhsa_user_sgpr_count 2
  .amdhsa_user_sgpr_kernarg_segment_ptr 1
  .amdhsa_system_sgpr_workgroup_id_x 1
.end_amdhsa_kernel
```
